```python
import torch

def _softmax(x, axis=-1):
    return torch.softmax(x, dim=axis)
def _gelu(x):
    return torch.nn.functional.gelu(x, approximate="tanh")
def _silu(x):
    return torch.nn.functional.silu(x)
def _sigmoid(x):
    return torch.sigmoid(x)
def _layernorm(x, axis=-1, eps=1e-5):
    m = x.mean(dim=axis, keepdim=True)
    v = x.var(dim=axis, keepdim=True, unbiased=False)
    return (x - m) / torch.sqrt(v + eps)
def _scatter_add(tgt, idx, src, axis=0):
    return tgt.clone().index_add_(axis, idx, src)
def _segment_sum(src, seg, n):
    out = torch.zeros((n,) + src.shape[1:], dtype=src.dtype)
    return out.index_add_(0, seg, src)
def _pad(x, pw):
    flat = tuple(v for pair in reversed(pw) for v in pair)
    return torch.nn.functional.pad(x, flat)

kernel_name = 'standalone__gqa_softmax__near_ridge'

def setup_inputs():

    _w = (lambda a: (lambda t: t.to(torch.bfloat16) if t.is_floating_point() else t)(torch.as_tensor(a)))
    B, Hq, Hkv, Sq, Sk, D = 8, 32, 32, 496, 512, 128
    return {
        "q": _w((lambda *s: torch.randn(*s, dtype=torch.bfloat16) * 0.8)(B, Hq, Sq, D)),
        "k": _w((lambda *s: torch.randn(*s, dtype=torch.bfloat16) * 0.8)(B, Hkv, Sk, D)),
        "v": _w((lambda *s: torch.randn(*s, dtype=torch.bfloat16) * 0.05)(B, Hkv, Sk, D)),
    }

def reference(q, k, v):
    B, Hq, Sq, D = q.shape
    Hkv = k.shape[1]
    rep = Hq // Hkv
    k = (lambda x, n, axis: torch.repeat_interleave(x, n, dim=axis))(k, rep, axis=1)
    v = (lambda x, n, axis: torch.repeat_interleave(x, n, dim=axis))(v, rep, axis=1)
    scale = D ** -0.5
    scores = torch.einsum("bhqd,bhkd->bhqk", q, k) * scale
    p = _softmax(scores, axis=-1)
    return torch.einsum("bhqk,bhkd->bhqd", p, v)
```

```asm
; @launch grid=(256,1,1) block=(256,1,1) lds=163840
.amdgcn_target "amdgcn-amd-amdhsa--gfx950"
.text
.globl standalone__gqa_softmax__near_ridge_kernel
.p2align 8
.type standalone__gqa_softmax__near_ridge_kernel,@function
standalone__gqa_softmax__near_ridge_kernel:
    s_cmp_ge_u32 s2, 256
    s_cbranch_scc1 L_END
    s_load_dwordx4 s[56:59], s[0:1], 0
    s_load_dwordx4 s[60:63], s[0:1], 16
    s_getpc_b64 s[52:53]
L_PC0:
    v_lshrrev_b32 v1, 6, v0
    s_lshr_b32 s54, s2, 3
    v_cmp_eq_u32 vcc, 0, v1
    v_mov_b32 v1, s54
    v_mul_u32_u24 v2, 43, v1
    v_lshrrev_b32 v2, 8, v2
    v_mul_u32_u24 v2, 6, v2
    v_sub_u32 v1, v1, v2
    s_and_saveexec_b64 s[54:55], vcc
    s_cbranch_execz L_NOPF
    v_and_b32 v2, 63, v0
    v_lshlrev_b32 v2, 6, v2
    v_lshl_add_u32 v1, v1, 12, v2
    v_min_u32 v1, L_FAST_END-L_PC0-4, v1
    v_mov_b32 v5, s53
    v_add_co_u32 v4, vcc, s52, v1
    s_nop 1
    v_addc_co_u32 v5, vcc, 0, v5, vcc
    global_load_dword v63, v[4:5], off
L_NOPF:
    s_mov_b64 exec, -1
    v_lshrrev_b32 v1, 6, v0
    v_and_b32 v62, 15, v0
    v_readfirstlane_b32 s32, v1
    v_bfe_u32 v3, v0, 4, 2
    v_lshl_add_u32 v33, v1, 3, v3
    v_add_u32 v34, 0, v33
    v_and_b32 v35, 15, v34
    v_xor_b32 v35, v35, v62
    v_lshlrev_b32 v35, 4, v35
    v_lshl_add_u32 v35, v34, 8, v35
    v_subrev_u32 v16, 0, v35
    v_add_u32 v34, 4, v33
    v_and_b32 v35, 15, v34
    v_xor_b32 v35, v35, v62
    v_lshlrev_b32 v35, 4, v35
    v_lshl_add_u32 v35, v34, 8, v35
    v_subrev_u32 v17, 1024, v35
    v_lshl_add_u32 v36, v1, 6, v3
    v_add_u32 v34, 0, v3
    v_xor_b32 v35, v34, v62
    v_lshlrev_b32 v35, 4, v35
    v_add_u32 v34, 0, v36
    v_lshl_add_u32 v20, v34, 8, v35
    v_add_u32 v34, 4, v3
    v_xor_b32 v35, v34, v62
    v_lshlrev_b32 v35, 4, v35
    v_add_u32 v34, 4, v36
    v_lshl_add_u32 v21, v34, 8, v35
    v_add_u32 v34, 8, v3
    v_xor_b32 v35, v34, v62
    v_lshlrev_b32 v35, 4, v35
    v_add_u32 v34, 8, v36
    v_lshl_add_u32 v22, v34, 8, v35
    v_add_u32 v34, 12, v3
    v_xor_b32 v35, v34, v62
    v_lshlrev_b32 v35, 4, v35
    v_add_u32 v34, 12, v36
    v_lshl_add_u32 v23, v34, 8, v35
    s_and_b32 s54, s2, 7
    s_lshr_b32 s55, s2, 3
    s_and_b32 s36, s55, 1
    s_and_b32 s55, s55, 30
    s_lshl_b32 s54, s54, 5
    s_add_u32 s54, s54, s55
    s_lshl_b32 s46, s54, 17
    s_add_u32 s47, s46, 0x40000
    s_mul_i32 s54, s54, 126976
    s_lshl_b32 s55, s36, 16
    s_add_u32 s40, s54, s55
    s_add_u32 s38, s54, 126976+65536
    s_sub_u32 s38, s38, s55
    s_lshl_b32 s55, s36, 12
    s_sub_u32 s41, 65536, s55
    s_add_u32 s39, s55, 61440
    s_lshl_b32 s44, s32, 11
    s_lshl_b32 s45, s32, 14
    s_add_u32 s45, s45, 98304
    s_waitcnt lgkmcnt(0)
    s_mov_b32 s8, s58
    s_and_b32 s9, s59, 0xffff
    s_mov_b32 s10, s47
    s_mov_b32 s11, 0x20000
    s_add_u32 s16, s56, s40
    s_addc_u32 s17, s57, 0
    s_and_b32 s17, s17, 0xffff
    s_mov_b32 s18, s41
    s_mov_b32 s19, 0x20000
    s_add_u32 m0, s44, 0
    s_add_u32 s53, s46, 0
    buffer_load_dwordx4 v16, s[8:11], s53 offen nt lds
    buffer_load_dwordx4 v17, s[8:11], s53 offen offset:1024 nt lds
    s_add_u32 m0, s44, 8192
    s_add_u32 s53, s46, 8192
    buffer_load_dwordx4 v16, s[8:11], s53 offen nt lds
    buffer_load_dwordx4 v17, s[8:11], s53 offen offset:1024 nt lds
    s_mov_b32 s53, 0
    s_add_u32 m0, s45, 0
    s_nop 0
    buffer_load_dwordx4 v20, s[16:19], s53 offen nt lds
    s_add_u32 m0, s45, 1024
    s_nop 0
    buffer_load_dwordx4 v21, s[16:19], s53 offen nt lds
    s_add_u32 m0, s45, 2048
    s_nop 0
    buffer_load_dwordx4 v22, s[16:19], s53 offen nt lds
    s_add_u32 m0, s45, 3072
    s_nop 0
    buffer_load_dwordx4 v23, s[16:19], s53 offen nt lds
    s_mov_b32 s53, 4096
    s_add_u32 m0, s45, 4096
    s_nop 0
    buffer_load_dwordx4 v20, s[16:19], s53 offen nt lds
    s_add_u32 m0, s45, 5120
    s_nop 0
    buffer_load_dwordx4 v21, s[16:19], s53 offen nt lds
    s_add_u32 m0, s45, 6144
    s_nop 0
    buffer_load_dwordx4 v22, s[16:19], s53 offen nt lds
    s_add_u32 m0, s45, 7168
    s_nop 0
    buffer_load_dwordx4 v23, s[16:19], s53 offen nt lds
    s_mov_b32 s12, s60
    s_and_b32 s13, s61, 0xffff
    s_mov_b32 s14, s47
    s_mov_b32 s15, 0x20000
    v_or_b32 v32, 0, v3
    v_xor_b32 v32, v32, v62
    v_lshlrev_b32 v32, 4, v32
    v_lshl_add_u32 v4, v62, 8, v32
    v_or_b32 v32, 4, v3
    v_xor_b32 v32, v32, v62
    v_lshlrev_b32 v32, 4, v32
    v_lshl_add_u32 v5, v62, 8, v32
    v_or_b32 v32, 8, v3
    v_xor_b32 v32, v32, v62
    v_lshlrev_b32 v32, 4, v32
    v_lshl_add_u32 v6, v62, 8, v32
    v_or_b32 v32, 12, v3
    v_xor_b32 v32, v32, v62
    v_lshlrev_b32 v32, 4, v32
    v_lshl_add_u32 v7, v62, 8, v32
    v_lshrrev_b32 v33, 2, v62
    v_lshl_add_u32 v34, v3, 2, v33
    v_and_b32 v35, 7, v34
    v_and_b32 v38, 3, v62
    v_lshlrev_b32 v38, 3, v38
    v_lshl_add_u32 v38, v34, 8, v38
    v_add_u32 v38, 65536, v38
    v_xor_b32 v32, 0, v35
    v_lshl_add_u32 v8, v32, 5, v38
    v_xor_b32 v32, 1, v35
    v_lshl_add_u32 v9, v32, 5, v38
    v_xor_b32 v32, 2, v35
    v_lshl_add_u32 v10, v32, 5, v38
    v_xor_b32 v32, 3, v35
    v_lshl_add_u32 v11, v32, 5, v38
    v_xor_b32 v32, 4, v35
    v_lshl_add_u32 v12, v32, 5, v38
    v_xor_b32 v32, 5, v35
    v_lshl_add_u32 v13, v32, 5, v38
    v_xor_b32 v32, 6, v35
    v_lshl_add_u32 v14, v32, 5, v38
    v_xor_b32 v32, 7, v35
    v_lshl_add_u32 v15, v32, 5, v38
    v_lshl_add_u32 v33, v1, 3, v3
    v_add_u32 v34, 0, v33
    v_and_b32 v35, 7, v34
    v_lshlrev_b32 v35, 1, v35
    v_xor_b32 v35, v35, v62
    v_lshlrev_b32 v35, 4, v35
    v_lshl_add_u32 v35, v34, 8, v35
    v_subrev_u32 v18, 0, v35
    v_add_u32 v34, 4, v33
    v_and_b32 v35, 7, v34
    v_lshlrev_b32 v35, 1, v35
    v_xor_b32 v35, v35, v62
    v_lshlrev_b32 v35, 4, v35
    v_lshl_add_u32 v35, v34, 8, v35
    v_subrev_u32 v19, 1024, v35
    v_and_b32 v32, 3, v62
    v_mov_b32 v33, 0x3f803f80
    v_cmp_eq_u32 vcc, 0, v32
    v_and_b32 v34, 63, v0
    v_lshlrev_b32 v34, 4, v34
    v_cndmask_b32 v33, 0, v33, vcc
    v_mov_b32 v44, v33
    v_mov_b32 v45, v33
    v_mov_b32 v46, v33
    v_mov_b32 v47, v33
    v_add_u32 v2, s45, v34
    s_mov_b32 s68, 0x3fff
    s_mov_b32 s34, 0x3e0293ee
    s_mov_b32 s35, 0x3e0293ee
    s_mov_b32 s37, 0
    s_add_u32 s28, s46, 49152
    s_add_u32 s29, s46, 24576
    s_add_u32 s31, s44, 65536
    s_mov_b32 s64, 0
    s_mov_b32 s65, 4096
    s_mov_b32 s66, 8192
    s_mov_b32 s67, 12288
    s_add_u32 s20, s62, s38
    s_addc_u32 s21, s63, 0
    s_and_b32 s21, s21, 0xffff
    s_mov_b32 s22, s39
    s_mov_b32 s23, 0x20000
    s_add_u32 s24, s62, s40
    s_addc_u32 s25, s63, 0
    s_and_b32 s25, s25, 0xffff
    s_mov_b32 s26, s41
    s_mov_b32 s27, 0x20000
    v_add_u32 v3, 12288, v2
    v_add_u32 v56, s45, v4
    v_add_u32 v57, s45, v5
    v_add_u32 v58, s45, v6
    v_add_u32 v59, s45, v7
    s_mov_b32 s53, 8192
    s_add_u32 m0, s45, 8192
    s_nop 0
    buffer_load_dwordx4 v20, s[16:19], s53 offen nt lds
    s_add_u32 m0, s45, 9216
    s_nop 0
    buffer_load_dwordx4 v21, s[16:19], s53 offen nt lds
    s_add_u32 m0, s45, 10240
    s_nop 0
    buffer_load_dwordx4 v22, s[16:19], s53 offen nt lds
    s_add_u32 m0, s45, 11264
    s_nop 0
    buffer_load_dwordx4 v23, s[16:19], s53 offen nt lds
    s_waitcnt vmcnt(8)
    ds_read_b128 v[96:99], v56 offset:0
    ds_read_b128 v[104:107], v57 offset:0
    ds_read_b128 v[112:115], v58 offset:0
    ds_read_b128 v[120:123], v59 offset:0
    s_waitcnt lgkmcnt(3)
    v_lshlrev_b32 v48, 16, v96
    v_and_b32 v49, 0xffff0000, v96
    v_lshlrev_b32 v50, 16, v97
    v_and_b32 v51, 0xffff0000, v97
    v_lshlrev_b32 v52, 16, v98
    v_and_b32 v53, 0xffff0000, v98
    v_lshlrev_b32 v54, 16, v99
    v_and_b32 v55, 0xffff0000, v99
    v_pk_mul_f32 v[48:49], v[48:49], s[34:35]
    v_pk_mul_f32 v[50:51], v[50:51], s[34:35]
    v_pk_mul_f32 v[52:53], v[52:53], s[34:35]
    v_pk_mul_f32 v[54:55], v[54:55], s[34:35]
    v_cvt_pk_bf16_f32 v96, v48, v49
    v_cvt_pk_bf16_f32 v97, v50, v51
    v_cvt_pk_bf16_f32 v98, v52, v53
    v_cvt_pk_bf16_f32 v99, v54, v55
    v_accvgpr_write_b32 a0, v96
    v_accvgpr_write_b32 a1, v97
    v_accvgpr_write_b32 a2, v98
    v_accvgpr_write_b32 a3, v99
    s_waitcnt lgkmcnt(2)
    v_lshlrev_b32 v48, 16, v104
    v_and_b32 v49, 0xffff0000, v104
    v_lshlrev_b32 v50, 16, v105
    v_and_b32 v51, 0xffff0000, v105
    v_lshlrev_b32 v52, 16, v106
    v_and_b32 v53, 0xffff0000, v106
    v_lshlrev_b32 v54, 16, v107
    v_and_b32 v55, 0xffff0000, v107
    v_pk_mul_f32 v[48:49], v[48:49], s[34:35]
    v_pk_mul_f32 v[50:51], v[50:51], s[34:35]
    v_pk_mul_f32 v[52:53], v[52:53], s[34:35]
    v_pk_mul_f32 v[54:55], v[54:55], s[34:35]
    v_cvt_pk_bf16_f32 v104, v48, v49
    v_cvt_pk_bf16_f32 v105, v50, v51
    v_cvt_pk_bf16_f32 v106, v52, v53
    v_cvt_pk_bf16_f32 v107, v54, v55
    v_accvgpr_write_b32 a4, v104
    v_accvgpr_write_b32 a5, v105
    v_accvgpr_write_b32 a6, v106
    v_accvgpr_write_b32 a7, v107
    s_waitcnt lgkmcnt(1)
    v_lshlrev_b32 v48, 16, v112
    v_and_b32 v49, 0xffff0000, v112
    v_lshlrev_b32 v50, 16, v113
    v_and_b32 v51, 0xffff0000, v113
    v_lshlrev_b32 v52, 16, v114
    v_and_b32 v53, 0xffff0000, v114
    v_lshlrev_b32 v54, 16, v115
    v_and_b32 v55, 0xffff0000, v115
    v_pk_mul_f32 v[48:49], v[48:49], s[34:35]
    v_pk_mul_f32 v[50:51], v[50:51], s[34:35]
    v_pk_mul_f32 v[52:53], v[52:53], s[34:35]
    v_pk_mul_f32 v[54:55], v[54:55], s[34:35]
    v_cvt_pk_bf16_f32 v112, v48, v49
    v_cvt_pk_bf16_f32 v113, v50, v51
    v_cvt_pk_bf16_f32 v114, v52, v53
    v_cvt_pk_bf16_f32 v115, v54, v55
    v_accvgpr_write_b32 a8, v112
    v_accvgpr_write_b32 a9, v113
    v_accvgpr_write_b32 a10, v114
    v_accvgpr_write_b32 a11, v115
    s_waitcnt lgkmcnt(0)
    v_lshlrev_b32 v48, 16, v120
    v_and_b32 v49, 0xffff0000, v120
    v_lshlrev_b32 v50, 16, v121
    v_and_b32 v51, 0xffff0000, v121
    v_lshlrev_b32 v52, 16, v122
    v_and_b32 v53, 0xffff0000, v122
    v_lshlrev_b32 v54, 16, v123
    v_and_b32 v55, 0xffff0000, v123
    v_pk_mul_f32 v[48:49], v[48:49], s[34:35]
    v_pk_mul_f32 v[50:51], v[50:51], s[34:35]
    v_pk_mul_f32 v[52:53], v[52:53], s[34:35]
    v_pk_mul_f32 v[54:55], v[54:55], s[34:35]
    v_cvt_pk_bf16_f32 v120, v48, v49
    v_cvt_pk_bf16_f32 v121, v50, v51
    v_cvt_pk_bf16_f32 v122, v52, v53
    v_cvt_pk_bf16_f32 v123, v54, v55
    v_accvgpr_write_b32 a12, v120
    v_accvgpr_write_b32 a13, v121
    v_accvgpr_write_b32 a14, v122
    v_accvgpr_write_b32 a15, v123
    s_mov_b32 s53, 12288
    s_add_u32 m0, s45, 12288
    s_nop 0
    buffer_load_dwordx4 v20, s[16:19], s53 offen nt lds
    s_add_u32 m0, s45, 13312
    s_nop 0
    buffer_load_dwordx4 v21, s[16:19], s53 offen nt lds
    s_add_u32 m0, s45, 14336
    s_nop 0
    buffer_load_dwordx4 v22, s[16:19], s53 offen nt lds
    s_add_u32 m0, s45, 15360
    s_nop 0
    buffer_load_dwordx4 v23, s[16:19], s53 offen nt lds
    s_waitcnt vmcnt(16)
    s_barrier
    ds_read_b128 a[64:67], v4 offset:0
    ds_read_b128 a[68:71], v5 offset:0
    ds_read_b128 a[72:75], v6 offset:0
    ds_read_b128 a[76:79], v7 offset:0
    ds_read_b128 a[80:83], v4 offset:4096
    ds_read_b128 a[84:87], v5 offset:4096
    ds_read_b128 a[88:91], v6 offset:4096
    ds_read_b128 a[92:95], v7 offset:4096
    s_waitcnt vmcnt(8)
    ds_read_b128 v[96:99], v56 offset:4096
    ds_read_b128 v[104:107], v57 offset:4096
    ds_read_b128 v[112:115], v58 offset:4096
    ds_read_b128 v[120:123], v59 offset:4096
    s_waitcnt lgkmcnt(3)
    v_lshlrev_b32 v48, 16, v96
    v_and_b32 v49, 0xffff0000, v96
    v_lshlrev_b32 v50, 16, v97
    v_and_b32 v51, 0xffff0000, v97
    v_lshlrev_b32 v52, 16, v98
    v_and_b32 v53, 0xffff0000, v98
    v_lshlrev_b32 v54, 16, v99
    v_and_b32 v55, 0xffff0000, v99
    v_pk_mul_f32 v[48:49], v[48:49], s[34:35]
    v_pk_mul_f32 v[50:51], v[50:51], s[34:35]
    v_pk_mul_f32 v[52:53], v[52:53], s[34:35]
    v_pk_mul_f32 v[54:55], v[54:55], s[34:35]
    v_cvt_pk_bf16_f32 v96, v48, v49
    v_cvt_pk_bf16_f32 v97, v50, v51
    v_cvt_pk_bf16_f32 v98, v52, v53
    v_cvt_pk_bf16_f32 v99, v54, v55
    v_accvgpr_write_b32 a16, v96
    v_accvgpr_write_b32 a17, v97
    v_accvgpr_write_b32 a18, v98
    v_accvgpr_write_b32 a19, v99
    s_waitcnt lgkmcnt(2)
    v_lshlrev_b32 v48, 16, v104
    v_and_b32 v49, 0xffff0000, v104
    v_lshlrev_b32 v50, 16, v105
    v_and_b32 v51, 0xffff0000, v105
    v_lshlrev_b32 v52, 16, v106
    v_and_b32 v53, 0xffff0000, v106
    v_lshlrev_b32 v54, 16, v107
    v_and_b32 v55, 0xffff0000, v107
    v_pk_mul_f32 v[48:49], v[48:49], s[34:35]
    v_pk_mul_f32 v[50:51], v[50:51], s[34:35]
    v_pk_mul_f32 v[52:53], v[52:53], s[34:35]
    v_pk_mul_f32 v[54:55], v[54:55], s[34:35]
    v_cvt_pk_bf16_f32 v104, v48, v49
    v_cvt_pk_bf16_f32 v105, v50, v51
    v_cvt_pk_bf16_f32 v106, v52, v53
    v_cvt_pk_bf16_f32 v107, v54, v55
    v_accvgpr_write_b32 a20, v104
    v_accvgpr_write_b32 a21, v105
    v_accvgpr_write_b32 a22, v106
    v_accvgpr_write_b32 a23, v107
    s_waitcnt lgkmcnt(1)
    v_lshlrev_b32 v48, 16, v112
    v_and_b32 v49, 0xffff0000, v112
    v_lshlrev_b32 v50, 16, v113
    v_and_b32 v51, 0xffff0000, v113
    v_lshlrev_b32 v52, 16, v114
    v_and_b32 v53, 0xffff0000, v114
    v_lshlrev_b32 v54, 16, v115
    v_and_b32 v55, 0xffff0000, v115
    v_pk_mul_f32 v[48:49], v[48:49], s[34:35]
    v_pk_mul_f32 v[50:51], v[50:51], s[34:35]
    v_pk_mul_f32 v[52:53], v[52:53], s[34:35]
    v_pk_mul_f32 v[54:55], v[54:55], s[34:35]
    v_cvt_pk_bf16_f32 v112, v48, v49
    v_cvt_pk_bf16_f32 v113, v50, v51
    v_cvt_pk_bf16_f32 v114, v52, v53
    v_cvt_pk_bf16_f32 v115, v54, v55
    v_accvgpr_write_b32 a24, v112
    v_accvgpr_write_b32 a25, v113
    v_accvgpr_write_b32 a26, v114
    v_accvgpr_write_b32 a27, v115
    s_waitcnt lgkmcnt(0)
    v_lshlrev_b32 v48, 16, v120
    v_and_b32 v49, 0xffff0000, v120
    v_lshlrev_b32 v50, 16, v121
    v_and_b32 v51, 0xffff0000, v121
    v_lshlrev_b32 v52, 16, v122
    v_and_b32 v53, 0xffff0000, v122
    v_lshlrev_b32 v54, 16, v123
    v_and_b32 v55, 0xffff0000, v123
    v_pk_mul_f32 v[48:49], v[48:49], s[34:35]
    v_pk_mul_f32 v[50:51], v[50:51], s[34:35]
    v_pk_mul_f32 v[52:53], v[52:53], s[34:35]
    v_pk_mul_f32 v[54:55], v[54:55], s[34:35]
    v_cvt_pk_bf16_f32 v120, v48, v49
    v_cvt_pk_bf16_f32 v121, v50, v51
    v_cvt_pk_bf16_f32 v122, v52, v53
    v_cvt_pk_bf16_f32 v123, v54, v55
    v_accvgpr_write_b32 a28, v120
    v_accvgpr_write_b32 a29, v121
    v_accvgpr_write_b32 a30, v122
    v_accvgpr_write_b32 a31, v123
    s_add_u32 m0, s44, 65536
    s_add_u32 s53, s46, 0
    buffer_load_dwordx4 v18, s[12:15], s53 offen nt lds
    buffer_load_dwordx4 v19, s[12:15], s53 offen offset:1024 nt lds
    s_add_u32 m0, s44, 16384
    s_add_u32 s53, s46, 16384
    buffer_load_dwordx4 v16, s[8:11], s53 offen nt lds
    buffer_load_dwordx4 v17, s[8:11], s53 offen offset:1024 nt lds
    v_mfma_f32_16x16x32_bf16 v[64:67], a[64:67], a[0:3], 0
    v_mfma_f32_16x16x32_bf16 v[64:67], a[68:71], a[4:7], v[64:67]
    v_mfma_f32_16x16x32_bf16 v[64:67], a[72:75], a[8:11], v[64:67]
    v_mfma_f32_16x16x32_bf16 v[64:67], a[76:79], a[12:15], v[64:67]
    v_mfma_f32_16x16x32_bf16 v[68:71], a[80:83], a[0:3], 0
    v_mfma_f32_16x16x32_bf16 v[68:71], a[84:87], a[4:7], v[68:71]
    v_mfma_f32_16x16x32_bf16 v[68:71], a[88:91], a[8:11], v[68:71]
    v_mfma_f32_16x16x32_bf16 v[68:71], a[92:95], a[12:15], v[68:71]
    v_mfma_f32_16x16x32_bf16 v[72:75], a[64:67], a[16:19], 0
    v_mfma_f32_16x16x32_bf16 v[72:75], a[68:71], a[20:23], v[72:75]
    v_mfma_f32_16x16x32_bf16 v[72:75], a[72:75], a[24:27], v[72:75]
    v_mfma_f32_16x16x32_bf16 v[72:75], a[76:79], a[28:31], v[72:75]
    v_mfma_f32_16x16x32_bf16 v[76:79], a[80:83], a[16:19], 0
    v_mfma_f32_16x16x32_bf16 v[76:79], a[84:87], a[20:23], v[76:79]
    v_mfma_f32_16x16x32_bf16 v[76:79], a[88:91], a[24:27], v[76:79]
    v_mfma_f32_16x16x32_bf16 v[76:79], a[92:95], a[28:31], v[76:79]
    s_waitcnt vmcnt(8)
    ds_read_b128 v[96:99], v56 offset:8192
    ds_read_b128 v[104:107], v57 offset:8192
    ds_read_b128 v[112:115], v58 offset:8192
    ds_read_b128 v[120:123], v59 offset:8192
    s_waitcnt lgkmcnt(3)
    v_lshlrev_b32 v48, 16, v96
    v_and_b32 v49, 0xffff0000, v96
    v_lshlrev_b32 v50, 16, v97
    v_and_b32 v51, 0xffff0000, v97
    v_lshlrev_b32 v52, 16, v98
    v_and_b32 v53, 0xffff0000, v98
    v_lshlrev_b32 v54, 16, v99
    v_and_b32 v55, 0xffff0000, v99
    v_pk_mul_f32 v[48:49], v[48:49], s[34:35]
    v_pk_mul_f32 v[50:51], v[50:51], s[34:35]
    v_pk_mul_f32 v[52:53], v[52:53], s[34:35]
    v_pk_mul_f32 v[54:55], v[54:55], s[34:35]
    v_cvt_pk_bf16_f32 v96, v48, v49
    v_cvt_pk_bf16_f32 v97, v50, v51
    v_cvt_pk_bf16_f32 v98, v52, v53
    v_cvt_pk_bf16_f32 v99, v54, v55
    v_accvgpr_write_b32 a32, v96
    v_accvgpr_write_b32 a33, v97
    v_accvgpr_write_b32 a34, v98
    v_accvgpr_write_b32 a35, v99
    s_waitcnt lgkmcnt(2)
    v_lshlrev_b32 v48, 16, v104
    v_and_b32 v49, 0xffff0000, v104
    v_lshlrev_b32 v50, 16, v105
    v_and_b32 v51, 0xffff0000, v105
    v_lshlrev_b32 v52, 16, v106
    v_and_b32 v53, 0xffff0000, v106
    v_lshlrev_b32 v54, 16, v107
    v_and_b32 v55, 0xffff0000, v107
    v_pk_mul_f32 v[48:49], v[48:49], s[34:35]
    v_pk_mul_f32 v[50:51], v[50:51], s[34:35]
    v_pk_mul_f32 v[52:53], v[52:53], s[34:35]
    v_pk_mul_f32 v[54:55], v[54:55], s[34:35]
    v_cvt_pk_bf16_f32 v104, v48, v49
    v_cvt_pk_bf16_f32 v105, v50, v51
    v_cvt_pk_bf16_f32 v106, v52, v53
    v_cvt_pk_bf16_f32 v107, v54, v55
    v_accvgpr_write_b32 a36, v104
    v_accvgpr_write_b32 a37, v105
    v_accvgpr_write_b32 a38, v106
    v_accvgpr_write_b32 a39, v107
    s_waitcnt lgkmcnt(1)
    v_lshlrev_b32 v48, 16, v112
    v_and_b32 v49, 0xffff0000, v112
    v_lshlrev_b32 v50, 16, v113
    v_and_b32 v51, 0xffff0000, v113
    v_lshlrev_b32 v52, 16, v114
    v_and_b32 v53, 0xffff0000, v114
    v_lshlrev_b32 v54, 16, v115
    v_and_b32 v55, 0xffff0000, v115
    v_pk_mul_f32 v[48:49], v[48:49], s[34:35]
    v_pk_mul_f32 v[50:51], v[50:51], s[34:35]
    v_pk_mul_f32 v[52:53], v[52:53], s[34:35]
    v_pk_mul_f32 v[54:55], v[54:55], s[34:35]
    v_cvt_pk_bf16_f32 v112, v48, v49
    v_cvt_pk_bf16_f32 v113, v50, v51
    v_cvt_pk_bf16_f32 v114, v52, v53
    v_cvt_pk_bf16_f32 v115, v54, v55
    v_accvgpr_write_b32 a40, v112
    v_accvgpr_write_b32 a41, v113
    v_accvgpr_write_b32 a42, v114
    v_accvgpr_write_b32 a43, v115
    s_waitcnt lgkmcnt(0)
    v_lshlrev_b32 v48, 16, v120
    v_and_b32 v49, 0xffff0000, v120
    v_lshlrev_b32 v50, 16, v121
    v_and_b32 v51, 0xffff0000, v121
    v_lshlrev_b32 v52, 16, v122
    v_and_b32 v53, 0xffff0000, v122
    v_lshlrev_b32 v54, 16, v123
    v_and_b32 v55, 0xffff0000, v123
    v_pk_mul_f32 v[48:49], v[48:49], s[34:35]
    v_pk_mul_f32 v[50:51], v[50:51], s[34:35]
    v_pk_mul_f32 v[52:53], v[52:53], s[34:35]
    v_pk_mul_f32 v[54:55], v[54:55], s[34:35]
    v_cvt_pk_bf16_f32 v120, v48, v49
    v_cvt_pk_bf16_f32 v121, v50, v51
    v_cvt_pk_bf16_f32 v122, v52, v53
    v_cvt_pk_bf16_f32 v123, v54, v55
    v_accvgpr_write_b32 a44, v120
    v_accvgpr_write_b32 a45, v121
    v_accvgpr_write_b32 a46, v122
    v_accvgpr_write_b32 a47, v123
    s_add_u32 m0, s44, 73728
    s_add_u32 s53, s46, 8192
    buffer_load_dwordx4 v18, s[12:15], s53 offen nt lds
    buffer_load_dwordx4 v19, s[12:15], s53 offen offset:1024 nt lds
    s_add_u32 m0, s44, 24576
    s_add_u32 s53, s46, 24576
    buffer_load_dwordx4 v16, s[8:11], s53 offen nt lds
    buffer_load_dwordx4 v17, s[8:11], s53 offen offset:1024 nt lds
    s_nop 0
    v_mfma_f32_16x16x32_bf16 v[80:83], a[64:67], a[32:35], 0
    v_mfma_f32_16x16x32_bf16 v[80:83], a[68:71], a[36:39], v[80:83]
    v_mfma_f32_16x16x32_bf16 v[80:83], a[72:75], a[40:43], v[80:83]
    v_mfma_f32_16x16x32_bf16 v[80:83], a[76:79], a[44:47], v[80:83]
    v_mfma_f32_16x16x32_bf16 v[84:87], a[80:83], a[32:35], 0
    v_mfma_f32_16x16x32_bf16 v[84:87], a[84:87], a[36:39], v[84:87]
    v_mfma_f32_16x16x32_bf16 v[84:87], a[88:91], a[40:43], v[84:87]
    v_mfma_f32_16x16x32_bf16 v[84:87], a[92:95], a[44:47], v[84:87]
    v_exp_f32 v64, v64
    v_exp_f32 v65, v65
    v_exp_f32 v66, v66
    v_cvt_pk_bf16_f32 v64, v64, v65
    v_exp_f32 v67, v67
    v_exp_f32 v68, v68
    v_cvt_pk_bf16_f32 v65, v66, v67
    v_exp_f32 v69, v69
    v_exp_f32 v70, v70
    v_cvt_pk_bf16_f32 v66, v68, v69
    v_exp_f32 v71, v71
    s_nop 0
    v_cvt_pk_bf16_f32 v67, v70, v71
    s_waitcnt vmcnt(8)
    ds_read_b128 v[96:99], v56 offset:12288
    ds_read_b128 v[104:107], v57 offset:12288
    ds_read_b128 v[112:115], v58 offset:12288
    ds_read_b128 v[120:123], v59 offset:12288
    s_waitcnt lgkmcnt(3)
    v_lshlrev_b32 v48, 16, v96
    v_and_b32 v49, 0xffff0000, v96
    v_lshlrev_b32 v50, 16, v97
    v_and_b32 v51, 0xffff0000, v97
    v_lshlrev_b32 v52, 16, v98
    v_and_b32 v53, 0xffff0000, v98
    v_lshlrev_b32 v54, 16, v99
    v_and_b32 v55, 0xffff0000, v99
    v_pk_mul_f32 v[48:49], v[48:49], s[34:35]
    v_pk_mul_f32 v[50:51], v[50:51], s[34:35]
    v_pk_mul_f32 v[52:53], v[52:53], s[34:35]
    v_pk_mul_f32 v[54:55], v[54:55], s[34:35]
    v_cvt_pk_bf16_f32 v96, v48, v49
    v_cvt_pk_bf16_f32 v97, v50, v51
    v_cvt_pk_bf16_f32 v98, v52, v53
    v_cvt_pk_bf16_f32 v99, v54, v55
    v_accvgpr_write_b32 a48, v96
    v_accvgpr_write_b32 a49, v97
    v_accvgpr_write_b32 a50, v98
    v_accvgpr_write_b32 a51, v99
    s_waitcnt lgkmcnt(2)
    v_lshlrev_b32 v48, 16, v104
    v_and_b32 v49, 0xffff0000, v104
    v_lshlrev_b32 v50, 16, v105
    v_and_b32 v51, 0xffff0000, v105
    v_lshlrev_b32 v52, 16, v106
    v_and_b32 v53, 0xffff0000, v106
    v_lshlrev_b32 v54, 16, v107
    v_and_b32 v55, 0xffff0000, v107
    v_pk_mul_f32 v[48:49], v[48:49], s[34:35]
    v_pk_mul_f32 v[50:51], v[50:51], s[34:35]
    v_pk_mul_f32 v[52:53], v[52:53], s[34:35]
    v_pk_mul_f32 v[54:55], v[54:55], s[34:35]
    v_cvt_pk_bf16_f32 v104, v48, v49
    v_cvt_pk_bf16_f32 v105, v50, v51
    v_cvt_pk_bf16_f32 v106, v52, v53
    v_cvt_pk_bf16_f32 v107, v54, v55
    v_accvgpr_write_b32 a52, v104
    v_accvgpr_write_b32 a53, v105
    v_accvgpr_write_b32 a54, v106
    v_accvgpr_write_b32 a55, v107
    s_waitcnt lgkmcnt(1)
    v_lshlrev_b32 v48, 16, v112
    v_and_b32 v49, 0xffff0000, v112
    v_lshlrev_b32 v50, 16, v113
    v_and_b32 v51, 0xffff0000, v113
    v_lshlrev_b32 v52, 16, v114
    v_and_b32 v53, 0xffff0000, v114
    v_lshlrev_b32 v54, 16, v115
    v_and_b32 v55, 0xffff0000, v115
    v_pk_mul_f32 v[48:49], v[48:49], s[34:35]
    v_pk_mul_f32 v[50:51], v[50:51], s[34:35]
    v_pk_mul_f32 v[52:53], v[52:53], s[34:35]
    v_pk_mul_f32 v[54:55], v[54:55], s[34:35]
    v_cvt_pk_bf16_f32 v112, v48, v49
    v_cvt_pk_bf16_f32 v113, v50, v51
    v_cvt_pk_bf16_f32 v114, v52, v53
    v_cvt_pk_bf16_f32 v115, v54, v55
    v_accvgpr_write_b32 a56, v112
    v_accvgpr_write_b32 a57, v113
    v_accvgpr_write_b32 a58, v114
    v_accvgpr_write_b32 a59, v115
    s_waitcnt lgkmcnt(0)
    v_lshlrev_b32 v48, 16, v120
    v_and_b32 v49, 0xffff0000, v120
    v_lshlrev_b32 v50, 16, v121
    v_and_b32 v51, 0xffff0000, v121
    v_lshlrev_b32 v52, 16, v122
    v_and_b32 v53, 0xffff0000, v122
    v_lshlrev_b32 v54, 16, v123
    v_and_b32 v55, 0xffff0000, v123
    v_pk_mul_f32 v[48:49], v[48:49], s[34:35]
    v_pk_mul_f32 v[50:51], v[50:51], s[34:35]
    v_pk_mul_f32 v[52:53], v[52:53], s[34:35]
    v_pk_mul_f32 v[54:55], v[54:55], s[34:35]
    v_cvt_pk_bf16_f32 v120, v48, v49
    v_cvt_pk_bf16_f32 v121, v50, v51
    v_cvt_pk_bf16_f32 v122, v52, v53
    v_cvt_pk_bf16_f32 v123, v54, v55
    v_accvgpr_write_b32 a60, v120
    v_accvgpr_write_b32 a61, v121
    v_accvgpr_write_b32 a62, v122
    v_accvgpr_write_b32 a63, v123
    s_add_u32 s16, s56, s38
    s_addc_u32 s17, s57, 0
    s_and_b32 s17, s17, 0xffff
    s_mov_b32 s18, s39
    s_mov_b32 s42, s45
    s_mov_b32 s43, 0
    s_add_u32 m0, s44, 81920
    s_add_u32 s53, s46, 16384
    buffer_load_dwordx4 v18, s[12:15], s53 offen nt lds
    buffer_load_dwordx4 v19, s[12:15], s53 offen offset:1024 nt lds
    s_add_u32 m0, s44, 32768
    s_add_u32 s53, s46, 32768
    buffer_load_dwordx4 v16, s[8:11], s53 offen nt lds
    buffer_load_dwordx4 v17, s[8:11], s53 offen offset:1024 nt lds
    v_mfma_f32_16x16x32_bf16 v[88:91], a[64:67], a[48:51], 0
    v_mfma_f32_16x16x32_bf16 v[88:91], a[68:71], a[52:55], v[88:91]
    v_mfma_f32_16x16x32_bf16 v[88:91], a[72:75], a[56:59], v[88:91]
    v_mfma_f32_16x16x32_bf16 v[88:91], a[76:79], a[60:63], v[88:91]
    v_mfma_f32_16x16x32_bf16 v[92:95], a[80:83], a[48:51], 0
    v_mfma_f32_16x16x32_bf16 v[92:95], a[84:87], a[52:55], v[92:95]
    v_mfma_f32_16x16x32_bf16 v[92:95], a[88:91], a[56:59], v[92:95]
    v_mfma_f32_16x16x32_bf16 v[92:95], a[92:95], a[60:63], v[92:95]
    ds_read_b128 a[64:67], v4 offset:8192
    ds_read_b128 a[68:71], v5 offset:8192
    ds_read_b128 a[72:75], v6 offset:8192
    ds_read_b128 a[76:79], v7 offset:8192
    ds_read_b128 a[80:83], v4 offset:12288
    ds_read_b128 a[84:87], v5 offset:12288
    ds_read_b128 a[88:91], v6 offset:12288
    ds_read_b128 a[92:95], v7 offset:12288
    v_exp_f32 v72, v72
    v_exp_f32 v73, v73
    v_exp_f32 v74, v74
    v_cvt_pk_bf16_f32 v72, v72, v73
    v_exp_f32 v75, v75
    v_exp_f32 v76, v76
    v_cvt_pk_bf16_f32 v73, v74, v75
    v_exp_f32 v77, v77
    v_exp_f32 v78, v78
    v_cvt_pk_bf16_f32 v74, v76, v77
    v_exp_f32 v79, v79
    s_nop 0
    v_cvt_pk_bf16_f32 v75, v78, v79
    s_add_u32 m0, s44, 40960
    s_add_u32 s53, s46, 40960
    buffer_load_dwordx4 v16, s[8:11], s53 offen nt lds
    buffer_load_dwordx4 v17, s[8:11], s53 offen offset:1024 nt lds
    v_exp_f32 v80, v80
    v_exp_f32 v81, v81
    v_exp_f32 v82, v82
    v_cvt_pk_bf16_f32 v80, v80, v81
    v_exp_f32 v83, v83
    v_exp_f32 v84, v84
    v_cvt_pk_bf16_f32 v81, v82, v83
    v_exp_f32 v85, v85
    v_exp_f32 v86, v86
    v_cvt_pk_bf16_f32 v82, v84, v85
    v_exp_f32 v87, v87
    s_nop 0
    v_cvt_pk_bf16_f32 v83, v86, v87
    s_waitcnt lgkmcnt(7)
    v_mfma_f32_16x16x32_bf16 v[96:99], a[64:67], a[0:3], 0
    s_waitcnt vmcnt(10)
    s_barrier
    s_waitcnt lgkmcnt(6)
    v_exp_f32 v88, v88
    v_mfma_f32_16x16x32_bf16 v[96:99], a[68:71], a[4:7], v[96:99]
    s_waitcnt lgkmcnt(5)
    ds_read_b64_tr_b16 a[96:97], v8 offset:0
    v_mfma_f32_16x16x32_bf16 v[96:99], a[72:75], a[8:11], v[96:99]
    s_waitcnt lgkmcnt(5)
    v_exp_f32 v89, v89
    v_mfma_f32_16x16x32_bf16 v[96:99], a[76:79], a[12:15], v[96:99]
    s_waitcnt lgkmcnt(4)
    ds_read_b64_tr_b16 a[98:99], v8 offset:4096
    v_cvt_pk_bf16_f32 v88, v88, v89
    v_mfma_f32_16x16x32_bf16 v[100:103], a[80:83], a[0:3], 0
    s_waitcnt lgkmcnt(4)
    s_add_u32 m0, s42, 0
    v_exp_f32 v90, v90
    v_mfma_f32_16x16x32_bf16 v[100:103], a[84:87], a[4:7], v[100:103]
    s_waitcnt lgkmcnt(3)
    ds_read_b64_tr_b16 a[100:101], v9 offset:0
    buffer_load_dwordx4 v20, s[16:19], s43 offen nt lds
    v_mfma_f32_16x16x32_bf16 v[100:103], a[88:91], a[8:11], v[100:103]
    s_waitcnt lgkmcnt(3)
    v_exp_f32 v91, v91
    v_mfma_f32_16x16x32_bf16 v[100:103], a[92:95], a[12:15], v[100:103]
    ds_read_b64_tr_b16 a[102:103], v9 offset:4096
    v_cvt_pk_bf16_f32 v89, v90, v91
    v_mfma_f32_16x16x32_bf16 v[104:107], a[64:67], a[16:19], 0
    s_add_u32 m0, s42, 1024
    v_exp_f32 v92, v92
    v_mfma_f32_16x16x32_bf16 v[104:107], a[68:71], a[20:23], v[104:107]
    ds_read_b64_tr_b16 a[104:105], v10 offset:0
    buffer_load_dwordx4 v21, s[16:19], s43 offen nt lds
    v_mfma_f32_16x16x32_bf16 v[104:107], a[72:75], a[24:27], v[104:107]
    v_exp_f32 v93, v93
    v_mfma_f32_16x16x32_bf16 v[104:107], a[76:79], a[28:31], v[104:107]
    ds_read_b64_tr_b16 a[106:107], v10 offset:4096
    v_cvt_pk_bf16_f32 v90, v92, v93
    v_mfma_f32_16x16x32_bf16 v[108:111], a[80:83], a[16:19], 0
    v_exp_f32 v94, v94
    v_mfma_f32_16x16x32_bf16 v[108:111], a[84:87], a[20:23], v[108:111]
    ds_read_b64_tr_b16 a[108:109], v11 offset:0
    v_mfma_f32_16x16x32_bf16 v[108:111], a[88:91], a[24:27], v[108:111]
    v_exp_f32 v95, v95
    v_mfma_f32_16x16x32_bf16 v[108:111], a[92:95], a[28:31], v[108:111]
    s_add_u32 m0, s31, 24576
    ds_read_b64_tr_b16 a[110:111], v11 offset:4096
    v_cvt_pk_bf16_f32 v91, v94, v95
    v_mfma_f32_16x16x32_bf16 v[112:115], a[64:67], a[32:35], 0
    buffer_load_dwordx4 v18, s[12:15], s29 offen nt lds
    v_mfma_f32_16x16x32_bf16 v[112:115], a[68:71], a[36:39], v[112:115]
    v_exp_f32 v96, v96
    v_mfma_f32_16x16x32_bf16 v[112:115], a[72:75], a[40:43], v[112:115]
    ds_read_b64_tr_b16 a[112:113], v12 offset:0
    v_mfma_f32_16x16x32_bf16 v[112:115], a[76:79], a[44:47], v[112:115]
    v_exp_f32 v97, v97
    v_mfma_f32_16x16x32_bf16 v[116:119], a[80:83], a[32:35], 0
    ds_read_b64_tr_b16 a[114:115], v12 offset:4096
    v_cvt_pk_bf16_f32 v96, v96, v97
    v_mfma_f32_16x16x32_bf16 v[116:119], a[84:87], a[36:39], v[116:119]
    v_exp_f32 v98, v98
    v_mfma_f32_16x16x32_bf16 v[116:119], a[88:91], a[40:43], v[116:119]
    ds_read_b64_tr_b16 a[116:117], v13 offset:0
    v_mfma_f32_16x16x32_bf16 v[116:119], a[92:95], a[44:47], v[116:119]
    v_exp_f32 v99, v99
    v_mfma_f32_16x16x32_bf16 v[120:123], a[64:67], a[48:51], 0
    ds_read_b64_tr_b16 a[118:119], v13 offset:4096
    v_cvt_pk_bf16_f32 v97, v98, v99
    v_mfma_f32_16x16x32_bf16 v[120:123], a[68:71], a[52:55], v[120:123]
    v_exp_f32 v100, v100
    v_mfma_f32_16x16x32_bf16 v[120:123], a[72:75], a[56:59], v[120:123]
    ds_read_b64_tr_b16 a[120:121], v14 offset:0
    v_mfma_f32_16x16x32_bf16 v[120:123], a[76:79], a[60:63], v[120:123]
    v_exp_f32 v101, v101
    v_mfma_f32_16x16x32_bf16 v[124:127], a[80:83], a[48:51], 0
    ds_read_b64_tr_b16 a[122:123], v14 offset:4096
    v_cvt_pk_bf16_f32 v98, v100, v101
    v_mfma_f32_16x16x32_bf16 v[124:127], a[84:87], a[52:55], v[124:127]
    v_exp_f32 v102, v102
    v_mfma_f32_16x16x32_bf16 v[124:127], a[88:91], a[56:59], v[124:127]
    ds_read_b64_tr_b16 a[124:125], v15 offset:0
    v_mfma_f32_16x16x32_bf16 v[124:127], a[92:95], a[60:63], v[124:127]
    v_exp_f32 v103, v103
    v_mfma_f32_16x16x32_bf16 v[28:31], v[44:47], v[64:67], 0
    s_waitcnt lgkmcnt(13)
    ds_read_b64_tr_b16 a[126:127], v15 offset:4096
    v_cvt_pk_bf16_f32 v99, v102, v103
    v_mfma_f32_16x16x32_bf16 v[128:131], a[96:99], v[64:67], 0
    s_waitcnt lgkmcnt(12)
    buffer_load_dwordx4 v19, s[12:15], s29 offen offset:1024 nt lds
    s_add_u32 s29, s29, 8192
    v_mfma_f32_16x16x32_bf16 v[132:135], a[100:103], v[64:67], 0
    s_waitcnt lgkmcnt(10)
    v_exp_f32 v104, v104
    v_mfma_f32_16x16x32_bf16 v[136:139], a[104:107], v[64:67], 0
    s_waitcnt lgkmcnt(8)
    ds_read_b128 a[64:67], v4 offset:16384
    v_mfma_f32_16x16x32_bf16 v[140:143], a[108:111], v[64:67], 0
    s_waitcnt lgkmcnt(7)
    v_exp_f32 v105, v105
    v_mfma_f32_16x16x32_bf16 v[144:147], a[112:115], v[64:67], 0
    s_waitcnt lgkmcnt(5)
    v_cvt_pk_bf16_f32 v104, v104, v105
    v_mfma_f32_16x16x32_bf16 v[148:151], a[116:119], v[64:67], 0
    s_waitcnt lgkmcnt(3)
    v_exp_f32 v106, v106
    v_mfma_f32_16x16x32_bf16 v[152:155], a[120:123], v[64:67], 0
    s_waitcnt lgkmcnt(1)
    ds_read_b128 a[68:71], v5 offset:16384
    v_mfma_f32_16x16x32_bf16 v[156:159], a[124:127], v[64:67], 0
    v_exp_f32 v107, v107
    v_mfma_f32_16x16x32_bf16 v[32:35], v[44:47], v[72:75], 0
    v_cvt_pk_bf16_f32 v105, v106, v107
    v_mfma_f32_16x16x32_bf16 v[160:163], a[96:99], v[72:75], 0
    v_exp_f32 v108, v108
    v_mfma_f32_16x16x32_bf16 v[164:167], a[100:103], v[72:75], 0
    ds_read_b128 a[72:75], v6 offset:16384
    v_mfma_f32_16x16x32_bf16 v[168:171], a[104:107], v[72:75], 0
    v_exp_f32 v109, v109
    v_mfma_f32_16x16x32_bf16 v[172:175], a[108:111], v[72:75], 0
    v_cvt_pk_bf16_f32 v106, v108, v109
    v_mfma_f32_16x16x32_bf16 v[176:179], a[112:115], v[72:75], 0
    v_exp_f32 v110, v110
    v_mfma_f32_16x16x32_bf16 v[180:183], a[116:119], v[72:75], 0
    ds_read_b128 a[76:79], v7 offset:16384
    v_mfma_f32_16x16x32_bf16 v[184:187], a[120:123], v[72:75], 0
    v_exp_f32 v111, v111
    v_mfma_f32_16x16x32_bf16 v[188:191], a[124:127], v[72:75], 0
    s_add_u32 m0, s44, 49152
    v_cvt_pk_bf16_f32 v107, v110, v111
    v_mfma_f32_16x16x32_bf16 v[36:39], v[44:47], v[80:83], 0
    buffer_load_dwordx4 v16, s[8:11], s28 offen nt lds
    v_mfma_f32_16x16x32_bf16 v[192:195], a[96:99], v[80:83], 0
    v_exp_f32 v112, v112
    v_mfma_f32_16x16x32_bf16 v[196:199], a[100:103], v[80:83], 0
    ds_read_b128 a[80:83], v4 offset:20480
    v_mfma_f32_16x16x32_bf16 v[200:203], a[104:107], v[80:83], 0
    v_exp_f32 v113, v113
    v_mfma_f32_16x16x32_bf16 v[204:207], a[108:111], v[80:83], 0
    v_cvt_pk_bf16_f32 v112, v112, v113
    v_mfma_f32_16x16x32_bf16 v[208:211], a[112:115], v[80:83], 0
    v_exp_f32 v114, v114
    v_mfma_f32_16x16x32_bf16 v[212:215], a[116:119], v[80:83], 0
    ds_read_b128 a[84:87], v5 offset:20480
    v_mfma_f32_16x16x32_bf16 v[216:219], a[120:123], v[80:83], 0
    v_exp_f32 v115, v115
    v_mfma_f32_16x16x32_bf16 v[220:223], a[124:127], v[80:83], 0
    v_cvt_pk_bf16_f32 v113, v114, v115
    v_mfma_f32_16x16x32_bf16 v[40:43], v[44:47], v[88:91], 0
    v_exp_f32 v116, v116
    v_mfma_f32_16x16x32_bf16 v[224:227], a[96:99], v[88:91], 0
    ds_read_b128 a[88:91], v6 offset:20480
    v_mfma_f32_16x16x32_bf16 v[228:231], a[100:103], v[88:91], 0
    v_exp_f32 v117, v117
    v_mfma_f32_16x16x32_bf16 v[232:235], a[104:107], v[88:91], 0
    v_cvt_pk_bf16_f32 v114, v116, v117
    v_mfma_f32_16x16x32_bf16 v[236:239], a[108:111], v[88:91], 0
    v_exp_f32 v118, v118
    v_mfma_f32_16x16x32_bf16 v[240:243], a[112:115], v[88:91], 0
    ds_read_b128 a[92:95], v7 offset:20480
    v_mfma_f32_16x16x32_bf16 v[244:247], a[116:119], v[88:91], 0
    v_exp_f32 v119, v119
    v_mfma_f32_16x16x32_bf16 v[248:251], a[120:123], v[88:91], 0
    v_cvt_pk_bf16_f32 v115, v118, v119
    v_mfma_f32_16x16x32_bf16 v[252:255], a[124:127], v[88:91], 0
    buffer_load_dwordx4 v17, s[8:11], s28 offen offset:1024 nt lds
    s_add_u32 s28, s28, 8192
    s_mov_b32 s33, 0
    s_mov_b32 s30, s44
    .p2align 6
L_LOOP0:
    s_waitcnt lgkmcnt(7)
    v_mfma_f32_16x16x32_bf16 v[64:67], a[64:67], a[0:3], 0
    s_waitcnt vmcnt(12)
    s_barrier
    s_waitcnt lgkmcnt(6)
    v_exp_f32 v120, v120
    v_mfma_f32_16x16x32_bf16 v[64:67], a[68:71], a[4:7], v[64:67]
    s_waitcnt lgkmcnt(5)
    ds_read_b64_tr_b16 a[96:97], v8 offset:8192
    v_mfma_f32_16x16x32_bf16 v[64:67], a[72:75], a[8:11], v[64:67]
    s_waitcnt lgkmcnt(5)
    v_exp_f32 v121, v121
    v_mfma_f32_16x16x32_bf16 v[64:67], a[76:79], a[12:15], v[64:67]
    s_waitcnt lgkmcnt(4)
    ds_read_b64_tr_b16 a[98:99], v8 offset:12288
    v_cvt_pk_bf16_f32 v120, v120, v121
    v_mfma_f32_16x16x32_bf16 v[68:71], a[80:83], a[0:3], 0
    s_waitcnt lgkmcnt(4)
    v_exp_f32 v122, v122
    v_mfma_f32_16x16x32_bf16 v[68:71], a[84:87], a[4:7], v[68:71]
    s_waitcnt lgkmcnt(3)
    ds_read_b64_tr_b16 a[100:101], v9 offset:8192
    ds_read_b128 v[24:27], v3 offset:2048
    v_mfma_f32_16x16x32_bf16 v[68:71], a[88:91], a[8:11], v[68:71]
    s_waitcnt lgkmcnt(4)
    v_exp_f32 v123, v123
    v_mfma_f32_16x16x32_bf16 v[68:71], a[92:95], a[12:15], v[68:71]
    ds_read_b64_tr_b16 a[102:103], v9 offset:12288
    v_cvt_pk_bf16_f32 v121, v122, v123
    v_mfma_f32_16x16x32_bf16 v[72:75], a[64:67], a[16:19], 0
    v_exp_f32 v124, v124
    v_mfma_f32_16x16x32_bf16 v[72:75], a[68:71], a[20:23], v[72:75]
    ds_read_b64_tr_b16 a[104:105], v10 offset:8192
    v_mfma_f32_16x16x32_bf16 v[72:75], a[72:75], a[24:27], v[72:75]
    v_exp_f32 v125, v125
    v_mfma_f32_16x16x32_bf16 v[72:75], a[76:79], a[28:31], v[72:75]
    ds_read_b64_tr_b16 a[106:107], v10 offset:12288
    v_cvt_pk_bf16_f32 v122, v124, v125
    v_mfma_f32_16x16x32_bf16 v[76:79], a[80:83], a[16:19], 0
    v_exp_f32 v126, v126
    v_mfma_f32_16x16x32_bf16 v[76:79], a[84:87], a[20:23], v[76:79]
    s_waitcnt lgkmcnt(3)
    ds_read_b64_tr_b16 a[108:109], v11 offset:8192
    v_lshlrev_b32 v48, 16, v24
    v_mfma_f32_16x16x32_bf16 v[76:79], a[88:91], a[24:27], v[76:79]
    v_exp_f32 v127, v127
    v_mfma_f32_16x16x32_bf16 v[76:79], a[92:95], a[28:31], v[76:79]
    s_add_u32 m0, s31, 0
    ds_read_b64_tr_b16 a[110:111], v11 offset:12288
    v_cvt_pk_bf16_f32 v123, v126, v127
    v_mfma_f32_16x16x32_bf16 v[80:83], a[64:67], a[32:35], 0
    buffer_load_dwordx4 v18, s[12:15], s29 offen nt lds
    v_mfma_f32_16x16x32_bf16 v[80:83], a[68:71], a[36:39], v[80:83]
    v_exp_f32 v64, v64
    v_mfma_f32_16x16x32_bf16 v[80:83], a[72:75], a[40:43], v[80:83]
    ds_read_b64_tr_b16 a[112:113], v12 offset:8192
    v_and_b32 v49, 0xffff0000, v24
    v_mfma_f32_16x16x32_bf16 v[80:83], a[76:79], a[44:47], v[80:83]
    v_exp_f32 v65, v65
    v_mfma_f32_16x16x32_bf16 v[84:87], a[80:83], a[32:35], 0
    ds_read_b64_tr_b16 a[114:115], v12 offset:12288
    v_cvt_pk_bf16_f32 v64, v64, v65
    v_mfma_f32_16x16x32_bf16 v[84:87], a[84:87], a[36:39], v[84:87]
    v_exp_f32 v66, v66
    v_mfma_f32_16x16x32_bf16 v[84:87], a[88:91], a[40:43], v[84:87]
    ds_read_b64_tr_b16 a[116:117], v13 offset:8192
    v_lshlrev_b32 v50, 16, v25
    v_mfma_f32_16x16x32_bf16 v[84:87], a[92:95], a[44:47], v[84:87]
    v_exp_f32 v67, v67
    v_mfma_f32_16x16x32_bf16 v[88:91], a[64:67], a[48:51], 0
    ds_read_b64_tr_b16 a[118:119], v13 offset:12288
    v_cvt_pk_bf16_f32 v65, v66, v67
    v_mfma_f32_16x16x32_bf16 v[88:91], a[68:71], a[52:55], v[88:91]
    v_exp_f32 v68, v68
    v_mfma_f32_16x16x32_bf16 v[88:91], a[72:75], a[56:59], v[88:91]
    ds_read_b64_tr_b16 a[120:121], v14 offset:8192
    v_and_b32 v51, 0xffff0000, v25
    v_mfma_f32_16x16x32_bf16 v[88:91], a[76:79], a[60:63], v[88:91]
    v_exp_f32 v69, v69
    v_mfma_f32_16x16x32_bf16 v[92:95], a[80:83], a[48:51], 0
    ds_read_b64_tr_b16 a[122:123], v14 offset:12288
    v_cvt_pk_bf16_f32 v66, v68, v69
    v_mfma_f32_16x16x32_bf16 v[92:95], a[84:87], a[52:55], v[92:95]
    v_exp_f32 v70, v70
    v_mfma_f32_16x16x32_bf16 v[92:95], a[88:91], a[56:59], v[92:95]
    ds_read_b64_tr_b16 a[124:125], v15 offset:8192
    v_lshlrev_b32 v52, 16, v26
    v_mfma_f32_16x16x32_bf16 v[92:95], a[92:95], a[60:63], v[92:95]
    v_exp_f32 v71, v71
    v_mfma_f32_16x16x32_bf16 v[28:31], v[44:47], v[96:99], v[28:31]
    ds_read_b64_tr_b16 a[126:127], v15 offset:12288
    v_cvt_pk_bf16_f32 v67, v70, v71
    v_mfma_f32_16x16x32_bf16 v[128:131], a[96:99], v[96:99], v[128:131]
    s_waitcnt lgkmcnt(12)
    buffer_load_dwordx4 v19, s[12:15], s29 offen offset:1024 nt lds
    s_add_u32 s29, s29, 8192
    v_mfma_f32_16x16x32_bf16 v[132:135], a[100:103], v[96:99], v[132:135]
    s_waitcnt lgkmcnt(10)
    v_exp_f32 v72, v72
    v_mfma_f32_16x16x32_bf16 v[136:139], a[104:107], v[96:99], v[136:139]
    s_waitcnt lgkmcnt(8)
    ds_read_b128 a[64:67], v4 offset:24576
    v_and_b32 v53, 0xffff0000, v26
    v_mfma_f32_16x16x32_bf16 v[140:143], a[108:111], v[96:99], v[140:143]
    s_waitcnt lgkmcnt(7)
    v_exp_f32 v73, v73
    v_mfma_f32_16x16x32_bf16 v[144:147], a[112:115], v[96:99], v[144:147]
    s_waitcnt lgkmcnt(5)
    v_cvt_pk_bf16_f32 v72, v72, v73
    v_lshlrev_b32 v54, 16, v27
    v_mfma_f32_16x16x32_bf16 v[148:151], a[116:119], v[96:99], v[148:151]
    s_waitcnt lgkmcnt(3)
    v_exp_f32 v74, v74
    v_mfma_f32_16x16x32_bf16 v[152:155], a[120:123], v[96:99], v[152:155]
    s_waitcnt lgkmcnt(1)
    ds_read_b128 a[68:71], v5 offset:24576
    v_and_b32 v55, 0xffff0000, v27
    v_mfma_f32_16x16x32_bf16 v[156:159], a[124:127], v[96:99], v[156:159]
    v_exp_f32 v75, v75
    v_mfma_f32_16x16x32_bf16 v[32:35], v[44:47], v[104:107], v[32:35]
    v_cvt_pk_bf16_f32 v73, v74, v75
    v_mul_f32 v48, s34, v48
    v_mfma_f32_16x16x32_bf16 v[160:163], a[96:99], v[104:107], v[160:163]
    v_exp_f32 v76, v76
    v_mfma_f32_16x16x32_bf16 v[164:167], a[100:103], v[104:107], v[164:167]
    ds_read_b128 a[72:75], v6 offset:24576
    v_mul_f32 v49, s34, v49
    v_mfma_f32_16x16x32_bf16 v[168:171], a[104:107], v[104:107], v[168:171]
    s_add_u32 m0, s42, 2048
    v_exp_f32 v77, v77
    v_mfma_f32_16x16x32_bf16 v[172:175], a[108:111], v[104:107], v[172:175]
    buffer_load_dwordx4 v22, s[16:19], s43 offen nt lds
    v_cvt_pk_bf16_f32 v74, v76, v77
    v_mfma_f32_16x16x32_bf16 v[176:179], a[112:115], v[104:107], v[176:179]
    v_exp_f32 v78, v78
    v_mfma_f32_16x16x32_bf16 v[180:183], a[116:119], v[104:107], v[180:183]
    ds_read_b128 a[76:79], v7 offset:24576
    v_mul_f32 v50, s34, v50
    v_mfma_f32_16x16x32_bf16 v[184:187], a[120:123], v[104:107], v[184:187]
    v_exp_f32 v79, v79
    v_mfma_f32_16x16x32_bf16 v[188:191], a[124:127], v[104:107], v[188:191]
    s_xor_b32 m0, s30, 57344
    v_cvt_pk_bf16_f32 v75, v78, v79
    v_mul_f32 v51, s34, v51
    v_mfma_f32_16x16x32_bf16 v[36:39], v[44:47], v[112:115], v[36:39]
    buffer_load_dwordx4 v16, s[8:11], s28 offen nt lds
    v_mfma_f32_16x16x32_bf16 v[192:195], a[96:99], v[112:115], v[192:195]
    v_exp_f32 v80, v80
    v_mfma_f32_16x16x32_bf16 v[196:199], a[100:103], v[112:115], v[196:199]
    ds_read_b128 a[80:83], v4 offset:28672
    v_mul_f32 v52, s34, v52
    v_mfma_f32_16x16x32_bf16 v[200:203], a[104:107], v[112:115], v[200:203]
    v_exp_f32 v81, v81
    v_mfma_f32_16x16x32_bf16 v[204:207], a[108:111], v[112:115], v[204:207]
    v_cvt_pk_bf16_f32 v80, v80, v81
    v_mul_f32 v53, s34, v53
    v_mfma_f32_16x16x32_bf16 v[208:211], a[112:115], v[112:115], v[208:211]
    v_exp_f32 v82, v82
    v_mfma_f32_16x16x32_bf16 v[212:215], a[116:119], v[112:115], v[212:215]
    ds_read_b128 a[84:87], v5 offset:28672
    v_mul_f32 v54, s34, v54
    v_mfma_f32_16x16x32_bf16 v[216:219], a[120:123], v[112:115], v[216:219]
    v_exp_f32 v83, v83
    v_mfma_f32_16x16x32_bf16 v[220:223], a[124:127], v[112:115], v[220:223]
    v_cvt_pk_bf16_f32 v81, v82, v83
    v_mul_f32 v55, s34, v55
    v_mfma_f32_16x16x32_bf16 v[40:43], v[44:47], v[120:123], v[40:43]
    v_exp_f32 v84, v84
    v_mfma_f32_16x16x32_bf16 v[224:227], a[96:99], v[120:123], v[224:227]
    ds_read_b128 a[88:91], v6 offset:28672
    v_cvt_pk_bf16_f32 v24, v48, v49
    v_mfma_f32_16x16x32_bf16 v[228:231], a[100:103], v[120:123], v[228:231]
    v_exp_f32 v85, v85
    v_mfma_f32_16x16x32_bf16 v[232:235], a[104:107], v[120:123], v[232:235]
    v_cvt_pk_bf16_f32 v82, v84, v85
    v_cvt_pk_bf16_f32 v25, v50, v51
    v_mfma_f32_16x16x32_bf16 v[236:239], a[108:111], v[120:123], v[236:239]
    v_exp_f32 v86, v86
    v_mfma_f32_16x16x32_bf16 v[240:243], a[112:115], v[120:123], v[240:243]
    ds_read_b128 a[92:95], v7 offset:28672
    v_cvt_pk_bf16_f32 v26, v52, v53
    v_mfma_f32_16x16x32_bf16 v[244:247], a[116:119], v[120:123], v[244:247]
    v_exp_f32 v87, v87
    v_mfma_f32_16x16x32_bf16 v[248:251], a[120:123], v[120:123], v[248:251]
    v_cvt_pk_bf16_f32 v83, v86, v87
    v_cvt_pk_bf16_f32 v27, v54, v55
    v_mfma_f32_16x16x32_bf16 v[252:255], a[124:127], v[120:123], v[252:255]
    buffer_load_dwordx4 v17, s[8:11], s28 offen offset:1024 nt lds
    s_add_u32 s28, s28, 8192
    ds_write_b128 v3, v[24:27] offset:2048
    s_waitcnt lgkmcnt(7)
    v_mfma_f32_16x16x32_bf16 v[96:99], a[64:67], a[0:3], 0
    s_waitcnt vmcnt(13)
    s_barrier
    s_waitcnt lgkmcnt(6)
    v_exp_f32 v88, v88
    v_mfma_f32_16x16x32_bf16 v[96:99], a[68:71], a[4:7], v[96:99]
    s_waitcnt lgkmcnt(5)
    ds_read_b64_tr_b16 a[96:97], v8 offset:16384
    v_xor_b32 v4, 0x8000, v4
    v_mfma_f32_16x16x32_bf16 v[96:99], a[72:75], a[8:11], v[96:99]
    s_waitcnt lgkmcnt(5)
    v_exp_f32 v89, v89
    v_mfma_f32_16x16x32_bf16 v[96:99], a[76:79], a[12:15], v[96:99]
    s_waitcnt lgkmcnt(4)
    ds_read_b64_tr_b16 a[98:99], v8 offset:20480
    v_cvt_pk_bf16_f32 v88, v88, v89
    v_mfma_f32_16x16x32_bf16 v[100:103], a[80:83], a[0:3], 0
    s_waitcnt lgkmcnt(4)
    v_exp_f32 v90, v90
    v_mfma_f32_16x16x32_bf16 v[100:103], a[84:87], a[4:7], v[100:103]
    s_waitcnt lgkmcnt(3)
    ds_read_b64_tr_b16 a[100:101], v9 offset:16384
    ds_read_b128 v[24:27], v3 offset:3072
    v_xor_b32 v5, 0x8000, v5
    v_mfma_f32_16x16x32_bf16 v[100:103], a[88:91], a[8:11], v[100:103]
    s_waitcnt lgkmcnt(4)
    v_exp_f32 v91, v91
    v_mfma_f32_16x16x32_bf16 v[100:103], a[92:95], a[12:15], v[100:103]
    ds_read_b64_tr_b16 a[102:103], v9 offset:20480
    v_cvt_pk_bf16_f32 v89, v90, v91
    v_mfma_f32_16x16x32_bf16 v[104:107], a[64:67], a[16:19], 0
    v_exp_f32 v92, v92
    v_mfma_f32_16x16x32_bf16 v[104:107], a[68:71], a[20:23], v[104:107]
    ds_read_b64_tr_b16 a[104:105], v10 offset:16384
    v_xor_b32 v6, 0x8000, v6
    v_mfma_f32_16x16x32_bf16 v[104:107], a[72:75], a[24:27], v[104:107]
    v_exp_f32 v93, v93
    v_mfma_f32_16x16x32_bf16 v[104:107], a[76:79], a[28:31], v[104:107]
    ds_read_b64_tr_b16 a[106:107], v10 offset:20480
    v_cvt_pk_bf16_f32 v90, v92, v93
    v_mfma_f32_16x16x32_bf16 v[108:111], a[80:83], a[16:19], 0
    v_exp_f32 v94, v94
    v_mfma_f32_16x16x32_bf16 v[108:111], a[84:87], a[20:23], v[108:111]
    s_waitcnt lgkmcnt(3)
    ds_read_b64_tr_b16 a[108:109], v11 offset:16384
    v_xor_b32 v7, 0x8000, v7
    v_lshlrev_b32 v48, 16, v24
    v_mfma_f32_16x16x32_bf16 v[108:111], a[88:91], a[24:27], v[108:111]
    v_exp_f32 v95, v95
    v_mfma_f32_16x16x32_bf16 v[108:111], a[92:95], a[28:31], v[108:111]
    s_add_u32 m0, s31, 8192
    ds_read_b64_tr_b16 a[110:111], v11 offset:20480
    v_cvt_pk_bf16_f32 v91, v94, v95
    v_mfma_f32_16x16x32_bf16 v[112:115], a[64:67], a[32:35], 0
    buffer_load_dwordx4 v18, s[12:15], s29 offen nt lds
    v_mfma_f32_16x16x32_bf16 v[112:115], a[68:71], a[36:39], v[112:115]
    v_exp_f32 v96, v96
    v_mfma_f32_16x16x32_bf16 v[112:115], a[72:75], a[40:43], v[112:115]
    ds_read_b64_tr_b16 a[112:113], v12 offset:16384
    v_and_b32 v49, 0xffff0000, v24
    v_mfma_f32_16x16x32_bf16 v[112:115], a[76:79], a[44:47], v[112:115]
    v_exp_f32 v97, v97
    v_mfma_f32_16x16x32_bf16 v[116:119], a[80:83], a[32:35], 0
    ds_read_b64_tr_b16 a[114:115], v12 offset:20480
    v_cvt_pk_bf16_f32 v96, v96, v97
    v_mfma_f32_16x16x32_bf16 v[116:119], a[84:87], a[36:39], v[116:119]
    v_exp_f32 v98, v98
    v_mfma_f32_16x16x32_bf16 v[116:119], a[88:91], a[40:43], v[116:119]
    ds_read_b64_tr_b16 a[116:117], v13 offset:16384
    v_lshlrev_b32 v50, 16, v25
    v_mfma_f32_16x16x32_bf16 v[116:119], a[92:95], a[44:47], v[116:119]
    v_exp_f32 v99, v99
    v_mfma_f32_16x16x32_bf16 v[120:123], a[64:67], a[48:51], 0
    ds_read_b64_tr_b16 a[118:119], v13 offset:20480
    v_cvt_pk_bf16_f32 v97, v98, v99
    v_mfma_f32_16x16x32_bf16 v[120:123], a[68:71], a[52:55], v[120:123]
    v_exp_f32 v100, v100
    v_mfma_f32_16x16x32_bf16 v[120:123], a[72:75], a[56:59], v[120:123]
    ds_read_b64_tr_b16 a[120:121], v14 offset:16384
    v_and_b32 v51, 0xffff0000, v25
    v_mfma_f32_16x16x32_bf16 v[120:123], a[76:79], a[60:63], v[120:123]
    v_exp_f32 v101, v101
    v_mfma_f32_16x16x32_bf16 v[124:127], a[80:83], a[48:51], 0
    ds_read_b64_tr_b16 a[122:123], v14 offset:20480
    v_cvt_pk_bf16_f32 v98, v100, v101
    v_mfma_f32_16x16x32_bf16 v[124:127], a[84:87], a[52:55], v[124:127]
    v_exp_f32 v102, v102
    v_mfma_f32_16x16x32_bf16 v[124:127], a[88:91], a[56:59], v[124:127]
    ds_read_b64_tr_b16 a[124:125], v15 offset:16384
    v_lshlrev_b32 v52, 16, v26
    v_mfma_f32_16x16x32_bf16 v[124:127], a[92:95], a[60:63], v[124:127]
    v_exp_f32 v103, v103
    v_mfma_f32_16x16x32_bf16 v[28:31], v[44:47], v[64:67], v[28:31]
    ds_read_b64_tr_b16 a[126:127], v15 offset:20480
    v_cvt_pk_bf16_f32 v99, v102, v103
    v_mfma_f32_16x16x32_bf16 v[128:131], a[96:99], v[64:67], v[128:131]
    s_waitcnt lgkmcnt(12)
    buffer_load_dwordx4 v19, s[12:15], s29 offen offset:1024 nt lds
    s_add_u32 s29, s29, 8192
    v_mfma_f32_16x16x32_bf16 v[132:135], a[100:103], v[64:67], v[132:135]
    s_waitcnt lgkmcnt(10)
    v_exp_f32 v104, v104
    v_mfma_f32_16x16x32_bf16 v[136:139], a[104:107], v[64:67], v[136:139]
    s_waitcnt lgkmcnt(8)
    ds_read_b128 a[64:67], v4 offset:0
    v_and_b32 v53, 0xffff0000, v26
    v_mfma_f32_16x16x32_bf16 v[140:143], a[108:111], v[64:67], v[140:143]
    s_waitcnt lgkmcnt(7)
    v_exp_f32 v105, v105
    v_mfma_f32_16x16x32_bf16 v[144:147], a[112:115], v[64:67], v[144:147]
    s_waitcnt lgkmcnt(5)
    v_cvt_pk_bf16_f32 v104, v104, v105
    v_lshlrev_b32 v54, 16, v27
    v_mfma_f32_16x16x32_bf16 v[148:151], a[116:119], v[64:67], v[148:151]
    s_waitcnt lgkmcnt(3)
    v_exp_f32 v106, v106
    v_mfma_f32_16x16x32_bf16 v[152:155], a[120:123], v[64:67], v[152:155]
    s_waitcnt lgkmcnt(1)
    ds_read_b128 a[68:71], v5 offset:0
    v_and_b32 v55, 0xffff0000, v27
    v_mfma_f32_16x16x32_bf16 v[156:159], a[124:127], v[64:67], v[156:159]
    v_exp_f32 v107, v107
    v_mfma_f32_16x16x32_bf16 v[32:35], v[44:47], v[72:75], v[32:35]
    v_cvt_pk_bf16_f32 v105, v106, v107
    v_mul_f32 v48, s34, v48
    v_mfma_f32_16x16x32_bf16 v[160:163], a[96:99], v[72:75], v[160:163]
    v_exp_f32 v108, v108
    v_mfma_f32_16x16x32_bf16 v[164:167], a[100:103], v[72:75], v[164:167]
    ds_read_b128 a[72:75], v6 offset:0
    v_mul_f32 v49, s34, v49
    v_mfma_f32_16x16x32_bf16 v[168:171], a[104:107], v[72:75], v[168:171]
    s_add_u32 m0, s42, 3072
    v_exp_f32 v109, v109
    v_mfma_f32_16x16x32_bf16 v[172:175], a[108:111], v[72:75], v[172:175]
    buffer_load_dwordx4 v23, s[16:19], s43 offen nt lds
    v_cvt_pk_bf16_f32 v106, v108, v109
    v_mfma_f32_16x16x32_bf16 v[176:179], a[112:115], v[72:75], v[176:179]
    v_exp_f32 v110, v110
    v_mfma_f32_16x16x32_bf16 v[180:183], a[116:119], v[72:75], v[180:183]
    ds_read_b128 a[76:79], v7 offset:0
    v_mul_f32 v50, s34, v50
    v_mfma_f32_16x16x32_bf16 v[184:187], a[120:123], v[72:75], v[184:187]
    v_exp_f32 v111, v111
    v_mfma_f32_16x16x32_bf16 v[188:191], a[124:127], v[72:75], v[188:191]
    s_xor_b32 m0, s30, 0
    v_cvt_pk_bf16_f32 v107, v110, v111
    v_mul_f32 v51, s34, v51
    v_mfma_f32_16x16x32_bf16 v[36:39], v[44:47], v[80:83], v[36:39]
    buffer_load_dwordx4 v16, s[8:11], s28 offen nt lds
    v_mfma_f32_16x16x32_bf16 v[192:195], a[96:99], v[80:83], v[192:195]
    v_exp_f32 v112, v112
    v_mfma_f32_16x16x32_bf16 v[196:199], a[100:103], v[80:83], v[196:199]
    ds_read_b128 a[80:83], v4 offset:4096
    v_mul_f32 v52, s34, v52
    v_mfma_f32_16x16x32_bf16 v[200:203], a[104:107], v[80:83], v[200:203]
    v_exp_f32 v113, v113
    v_mfma_f32_16x16x32_bf16 v[204:207], a[108:111], v[80:83], v[204:207]
    v_cvt_pk_bf16_f32 v112, v112, v113
    v_mul_f32 v53, s34, v53
    v_mfma_f32_16x16x32_bf16 v[208:211], a[112:115], v[80:83], v[208:211]
    v_exp_f32 v114, v114
    v_mfma_f32_16x16x32_bf16 v[212:215], a[116:119], v[80:83], v[212:215]
    ds_read_b128 a[84:87], v5 offset:4096
    v_mul_f32 v54, s34, v54
    v_mfma_f32_16x16x32_bf16 v[216:219], a[120:123], v[80:83], v[216:219]
    v_exp_f32 v115, v115
    v_mfma_f32_16x16x32_bf16 v[220:223], a[124:127], v[80:83], v[220:223]
    v_cvt_pk_bf16_f32 v113, v114, v115
    v_mul_f32 v55, s34, v55
    v_mfma_f32_16x16x32_bf16 v[40:43], v[44:47], v[88:91], v[40:43]
    v_exp_f32 v116, v116
    v_mfma_f32_16x16x32_bf16 v[224:227], a[96:99], v[88:91], v[224:227]
    ds_read_b128 a[88:91], v6 offset:4096
    v_cvt_pk_bf16_f32 v24, v48, v49
    v_mfma_f32_16x16x32_bf16 v[228:231], a[100:103], v[88:91], v[228:231]
    v_exp_f32 v117, v117
    v_mfma_f32_16x16x32_bf16 v[232:235], a[104:107], v[88:91], v[232:235]
    v_cvt_pk_bf16_f32 v114, v116, v117
    v_cvt_pk_bf16_f32 v25, v50, v51
    v_mfma_f32_16x16x32_bf16 v[236:239], a[108:111], v[88:91], v[236:239]
    v_exp_f32 v118, v118
    v_mfma_f32_16x16x32_bf16 v[240:243], a[112:115], v[88:91], v[240:243]
    ds_read_b128 a[92:95], v7 offset:4096
    v_cvt_pk_bf16_f32 v26, v52, v53
    v_mfma_f32_16x16x32_bf16 v[244:247], a[116:119], v[88:91], v[244:247]
    v_exp_f32 v119, v119
    v_mfma_f32_16x16x32_bf16 v[248:251], a[120:123], v[88:91], v[248:251]
    v_cvt_pk_bf16_f32 v115, v118, v119
    v_cvt_pk_bf16_f32 v27, v54, v55
    v_mfma_f32_16x16x32_bf16 v[252:255], a[124:127], v[88:91], v[252:255]
    buffer_load_dwordx4 v17, s[8:11], s28 offen offset:1024 nt lds
    s_add_u32 s28, s28, 8192
    ds_write_b128 v3, v[24:27] offset:3072
    s_cmp_eq_u32 s33, 3
    s_cbranch_scc1 L_DRAIN0
    s_waitcnt lgkmcnt(7)
    v_mfma_f32_16x16x32_bf16 v[64:67], a[64:67], a[0:3], 0
    s_waitcnt vmcnt(12)
    s_barrier
    s_waitcnt lgkmcnt(6)
    v_exp_f32 v120, v120
    v_mfma_f32_16x16x32_bf16 v[64:67], a[68:71], a[4:7], v[64:67]
    s_waitcnt lgkmcnt(5)
    ds_read_b64_tr_b16 a[96:97], v8 offset:24576
    v_add_u32 v56, 4096, v3
    v_mfma_f32_16x16x32_bf16 v[64:67], a[72:75], a[8:11], v[64:67]
    s_waitcnt lgkmcnt(5)
    v_exp_f32 v121, v121
    v_mfma_f32_16x16x32_bf16 v[64:67], a[76:79], a[12:15], v[64:67]
    s_waitcnt lgkmcnt(4)
    ds_read_b64_tr_b16 a[98:99], v8 offset:28672
    v_cvt_pk_bf16_f32 v120, v120, v121
    v_bfi_b32 v3, s68, v56, v3
    v_mfma_f32_16x16x32_bf16 v[68:71], a[80:83], a[0:3], 0
    s_waitcnt lgkmcnt(4)
    v_exp_f32 v122, v122
    v_mfma_f32_16x16x32_bf16 v[68:71], a[84:87], a[4:7], v[68:71]
    s_waitcnt lgkmcnt(3)
    ds_read_b64_tr_b16 a[100:101], v9 offset:24576
    ds_read_b128 v[24:27], v3 offset:0
    v_mfma_f32_16x16x32_bf16 v[68:71], a[88:91], a[8:11], v[68:71]
    s_waitcnt lgkmcnt(4)
    v_exp_f32 v123, v123
    v_mfma_f32_16x16x32_bf16 v[68:71], a[92:95], a[12:15], v[68:71]
    ds_read_b64_tr_b16 a[102:103], v9 offset:28672
    v_cvt_pk_bf16_f32 v121, v122, v123
    v_mfma_f32_16x16x32_bf16 v[72:75], a[64:67], a[16:19], 0
    v_exp_f32 v124, v124
    v_mfma_f32_16x16x32_bf16 v[72:75], a[68:71], a[20:23], v[72:75]
    ds_read_b64_tr_b16 a[104:105], v10 offset:24576
    v_mfma_f32_16x16x32_bf16 v[72:75], a[72:75], a[24:27], v[72:75]
    v_exp_f32 v125, v125
    v_mfma_f32_16x16x32_bf16 v[72:75], a[76:79], a[28:31], v[72:75]
    ds_read_b64_tr_b16 a[106:107], v10 offset:28672
    v_cvt_pk_bf16_f32 v122, v124, v125
    v_mfma_f32_16x16x32_bf16 v[76:79], a[80:83], a[16:19], 0
    v_exp_f32 v126, v126
    v_mfma_f32_16x16x32_bf16 v[76:79], a[84:87], a[20:23], v[76:79]
    s_waitcnt lgkmcnt(3)
    ds_read_b64_tr_b16 a[108:109], v11 offset:24576
    v_lshlrev_b32 v48, 16, v24
    v_mfma_f32_16x16x32_bf16 v[76:79], a[88:91], a[24:27], v[76:79]
    v_exp_f32 v127, v127
    v_mfma_f32_16x16x32_bf16 v[76:79], a[92:95], a[28:31], v[76:79]
    s_add_u32 m0, s31, 16384
    ds_read_b64_tr_b16 a[110:111], v11 offset:28672
    v_cvt_pk_bf16_f32 v123, v126, v127
    v_mfma_f32_16x16x32_bf16 v[80:83], a[64:67], a[32:35], 0
    buffer_load_dwordx4 v18, s[12:15], s29 offen nt lds
    v_mfma_f32_16x16x32_bf16 v[80:83], a[68:71], a[36:39], v[80:83]
    v_exp_f32 v64, v64
    v_mfma_f32_16x16x32_bf16 v[80:83], a[72:75], a[40:43], v[80:83]
    ds_read_b64_tr_b16 a[112:113], v12 offset:24576
    v_and_b32 v49, 0xffff0000, v24
    v_mfma_f32_16x16x32_bf16 v[80:83], a[76:79], a[44:47], v[80:83]
    v_exp_f32 v65, v65
    v_mfma_f32_16x16x32_bf16 v[84:87], a[80:83], a[32:35], 0
    ds_read_b64_tr_b16 a[114:115], v12 offset:28672
    v_cvt_pk_bf16_f32 v64, v64, v65
    v_mfma_f32_16x16x32_bf16 v[84:87], a[84:87], a[36:39], v[84:87]
    v_exp_f32 v66, v66
    v_mfma_f32_16x16x32_bf16 v[84:87], a[88:91], a[40:43], v[84:87]
    ds_read_b64_tr_b16 a[116:117], v13 offset:24576
    v_lshlrev_b32 v50, 16, v25
    v_mfma_f32_16x16x32_bf16 v[84:87], a[92:95], a[44:47], v[84:87]
    v_exp_f32 v67, v67
    v_mfma_f32_16x16x32_bf16 v[88:91], a[64:67], a[48:51], 0
    ds_read_b64_tr_b16 a[118:119], v13 offset:28672
    v_cvt_pk_bf16_f32 v65, v66, v67
    v_mfma_f32_16x16x32_bf16 v[88:91], a[68:71], a[52:55], v[88:91]
    v_exp_f32 v68, v68
    v_mfma_f32_16x16x32_bf16 v[88:91], a[72:75], a[56:59], v[88:91]
    ds_read_b64_tr_b16 a[120:121], v14 offset:24576
    v_and_b32 v51, 0xffff0000, v25
    v_mfma_f32_16x16x32_bf16 v[88:91], a[76:79], a[60:63], v[88:91]
    v_exp_f32 v69, v69
    v_mfma_f32_16x16x32_bf16 v[92:95], a[80:83], a[48:51], 0
    ds_read_b64_tr_b16 a[122:123], v14 offset:28672
    v_cvt_pk_bf16_f32 v66, v68, v69
    v_mfma_f32_16x16x32_bf16 v[92:95], a[84:87], a[52:55], v[92:95]
    v_exp_f32 v70, v70
    v_mfma_f32_16x16x32_bf16 v[92:95], a[88:91], a[56:59], v[92:95]
    ds_read_b64_tr_b16 a[124:125], v15 offset:24576
    v_lshlrev_b32 v52, 16, v26
    v_mfma_f32_16x16x32_bf16 v[92:95], a[92:95], a[60:63], v[92:95]
    v_exp_f32 v71, v71
    v_mfma_f32_16x16x32_bf16 v[28:31], v[44:47], v[96:99], v[28:31]
    ds_read_b64_tr_b16 a[126:127], v15 offset:28672
    v_cvt_pk_bf16_f32 v67, v70, v71
    v_mfma_f32_16x16x32_bf16 v[128:131], a[96:99], v[96:99], v[128:131]
    s_waitcnt lgkmcnt(12)
    buffer_load_dwordx4 v19, s[12:15], s29 offen offset:1024 nt lds
    s_add_u32 s29, s29, 8192
    v_mfma_f32_16x16x32_bf16 v[132:135], a[100:103], v[96:99], v[132:135]
    s_waitcnt lgkmcnt(10)
    v_exp_f32 v72, v72
    v_mfma_f32_16x16x32_bf16 v[136:139], a[104:107], v[96:99], v[136:139]
    s_waitcnt lgkmcnt(8)
    ds_read_b128 a[64:67], v4 offset:8192
    v_and_b32 v53, 0xffff0000, v26
    v_mfma_f32_16x16x32_bf16 v[140:143], a[108:111], v[96:99], v[140:143]
    s_waitcnt lgkmcnt(7)
    v_exp_f32 v73, v73
    v_mfma_f32_16x16x32_bf16 v[144:147], a[112:115], v[96:99], v[144:147]
    s_waitcnt lgkmcnt(5)
    v_cvt_pk_bf16_f32 v72, v72, v73
    v_lshlrev_b32 v54, 16, v27
    v_mfma_f32_16x16x32_bf16 v[148:151], a[116:119], v[96:99], v[148:151]
    s_waitcnt lgkmcnt(3)
    v_exp_f32 v74, v74
    v_mfma_f32_16x16x32_bf16 v[152:155], a[120:123], v[96:99], v[152:155]
    s_waitcnt lgkmcnt(1)
    ds_read_b128 a[68:71], v5 offset:8192
    v_and_b32 v55, 0xffff0000, v27
    v_mfma_f32_16x16x32_bf16 v[156:159], a[124:127], v[96:99], v[156:159]
    v_exp_f32 v75, v75
    v_mfma_f32_16x16x32_bf16 v[32:35], v[44:47], v[104:107], v[32:35]
    v_cvt_pk_bf16_f32 v73, v74, v75
    v_mul_f32 v48, s34, v48
    v_mfma_f32_16x16x32_bf16 v[160:163], a[96:99], v[104:107], v[160:163]
    v_exp_f32 v76, v76
    v_mfma_f32_16x16x32_bf16 v[164:167], a[100:103], v[104:107], v[164:167]
    ds_read_b128 a[72:75], v6 offset:8192
    v_mul_f32 v49, s34, v49
    v_mfma_f32_16x16x32_bf16 v[168:171], a[104:107], v[104:107], v[168:171]
    s_add_u32 s42, s42, 4096
    s_add_u32 s43, s43, 4096
    s_add_u32 m0, s42, 0
    v_exp_f32 v77, v77
    v_mfma_f32_16x16x32_bf16 v[172:175], a[108:111], v[104:107], v[172:175]
    buffer_load_dwordx4 v20, s[16:19], s43 offen nt lds
    v_cvt_pk_bf16_f32 v74, v76, v77
    v_mfma_f32_16x16x32_bf16 v[176:179], a[112:115], v[104:107], v[176:179]
    v_exp_f32 v78, v78
    v_mfma_f32_16x16x32_bf16 v[180:183], a[116:119], v[104:107], v[180:183]
    ds_read_b128 a[76:79], v7 offset:8192
    v_mul_f32 v50, s34, v50
    v_mfma_f32_16x16x32_bf16 v[184:187], a[120:123], v[104:107], v[184:187]
    v_exp_f32 v79, v79
    v_mfma_f32_16x16x32_bf16 v[188:191], a[124:127], v[104:107], v[188:191]
    s_xor_b32 m0, s30, 8192
    v_cvt_pk_bf16_f32 v75, v78, v79
    v_mul_f32 v51, s34, v51
    v_mfma_f32_16x16x32_bf16 v[36:39], v[44:47], v[112:115], v[36:39]
    buffer_load_dwordx4 v16, s[8:11], s28 offen nt lds
    v_mfma_f32_16x16x32_bf16 v[192:195], a[96:99], v[112:115], v[192:195]
    v_exp_f32 v80, v80
    v_mfma_f32_16x16x32_bf16 v[196:199], a[100:103], v[112:115], v[196:199]
    ds_read_b128 a[80:83], v4 offset:12288
    v_mul_f32 v52, s34, v52
    v_mfma_f32_16x16x32_bf16 v[200:203], a[104:107], v[112:115], v[200:203]
    v_exp_f32 v81, v81
    v_mfma_f32_16x16x32_bf16 v[204:207], a[108:111], v[112:115], v[204:207]
    v_cvt_pk_bf16_f32 v80, v80, v81
    v_mul_f32 v53, s34, v53
    v_mfma_f32_16x16x32_bf16 v[208:211], a[112:115], v[112:115], v[208:211]
    v_exp_f32 v82, v82
    v_mfma_f32_16x16x32_bf16 v[212:215], a[116:119], v[112:115], v[212:215]
    ds_read_b128 a[84:87], v5 offset:12288
    v_mul_f32 v54, s34, v54
    v_mfma_f32_16x16x32_bf16 v[216:219], a[120:123], v[112:115], v[216:219]
    v_exp_f32 v83, v83
    v_mfma_f32_16x16x32_bf16 v[220:223], a[124:127], v[112:115], v[220:223]
    v_cvt_pk_bf16_f32 v81, v82, v83
    v_mul_f32 v55, s34, v55
    v_mfma_f32_16x16x32_bf16 v[40:43], v[44:47], v[120:123], v[40:43]
    v_exp_f32 v84, v84
    v_mfma_f32_16x16x32_bf16 v[224:227], a[96:99], v[120:123], v[224:227]
    ds_read_b128 a[88:91], v6 offset:12288
    v_cvt_pk_bf16_f32 v24, v48, v49
    v_mfma_f32_16x16x32_bf16 v[228:231], a[100:103], v[120:123], v[228:231]
    v_exp_f32 v85, v85
    v_mfma_f32_16x16x32_bf16 v[232:235], a[104:107], v[120:123], v[232:235]
    v_cvt_pk_bf16_f32 v82, v84, v85
    v_cvt_pk_bf16_f32 v25, v50, v51
    v_mfma_f32_16x16x32_bf16 v[236:239], a[108:111], v[120:123], v[236:239]
    v_exp_f32 v86, v86
    v_mfma_f32_16x16x32_bf16 v[240:243], a[112:115], v[120:123], v[240:243]
    ds_read_b128 a[92:95], v7 offset:12288
    v_cvt_pk_bf16_f32 v26, v52, v53
    v_mfma_f32_16x16x32_bf16 v[244:247], a[116:119], v[120:123], v[244:247]
    v_exp_f32 v87, v87
    v_mfma_f32_16x16x32_bf16 v[248:251], a[120:123], v[120:123], v[248:251]
    v_cvt_pk_bf16_f32 v83, v86, v87
    v_cvt_pk_bf16_f32 v27, v54, v55
    v_mfma_f32_16x16x32_bf16 v[252:255], a[124:127], v[120:123], v[252:255]
    buffer_load_dwordx4 v17, s[8:11], s28 offen offset:1024 nt lds
    s_add_u32 s28, s28, 8192
    ds_write_b128 v3, v[24:27] offset:0
    s_waitcnt lgkmcnt(7)
    v_mfma_f32_16x16x32_bf16 v[96:99], a[64:67], a[0:3], 0
    s_waitcnt vmcnt(13)
    s_barrier
    s_waitcnt lgkmcnt(6)
    v_exp_f32 v88, v88
    v_mfma_f32_16x16x32_bf16 v[96:99], a[68:71], a[4:7], v[96:99]
    s_waitcnt lgkmcnt(5)
    ds_read_b64_tr_b16 a[96:97], v8 offset:0
    v_mfma_f32_16x16x32_bf16 v[96:99], a[72:75], a[8:11], v[96:99]
    s_waitcnt lgkmcnt(5)
    v_exp_f32 v89, v89
    v_mfma_f32_16x16x32_bf16 v[96:99], a[76:79], a[12:15], v[96:99]
    s_waitcnt lgkmcnt(4)
    ds_read_b64_tr_b16 a[98:99], v8 offset:4096
    v_cvt_pk_bf16_f32 v88, v88, v89
    v_mfma_f32_16x16x32_bf16 v[100:103], a[80:83], a[0:3], 0
    s_waitcnt lgkmcnt(4)
    v_exp_f32 v90, v90
    v_mfma_f32_16x16x32_bf16 v[100:103], a[84:87], a[4:7], v[100:103]
    s_waitcnt lgkmcnt(3)
    ds_read_b64_tr_b16 a[100:101], v9 offset:0
    ds_read_b128 v[24:27], v3 offset:1024
    v_mfma_f32_16x16x32_bf16 v[100:103], a[88:91], a[8:11], v[100:103]
    s_waitcnt lgkmcnt(4)
    v_exp_f32 v91, v91
    v_mfma_f32_16x16x32_bf16 v[100:103], a[92:95], a[12:15], v[100:103]
    ds_read_b64_tr_b16 a[102:103], v9 offset:4096
    v_cvt_pk_bf16_f32 v89, v90, v91
    v_mfma_f32_16x16x32_bf16 v[104:107], a[64:67], a[16:19], 0
    v_exp_f32 v92, v92
    v_mfma_f32_16x16x32_bf16 v[104:107], a[68:71], a[20:23], v[104:107]
    ds_read_b64_tr_b16 a[104:105], v10 offset:0
    v_mfma_f32_16x16x32_bf16 v[104:107], a[72:75], a[24:27], v[104:107]
    v_exp_f32 v93, v93
    v_mfma_f32_16x16x32_bf16 v[104:107], a[76:79], a[28:31], v[104:107]
    ds_read_b64_tr_b16 a[106:107], v10 offset:4096
    v_cvt_pk_bf16_f32 v90, v92, v93
    v_mfma_f32_16x16x32_bf16 v[108:111], a[80:83], a[16:19], 0
    v_exp_f32 v94, v94
    v_mfma_f32_16x16x32_bf16 v[108:111], a[84:87], a[20:23], v[108:111]
    s_waitcnt lgkmcnt(3)
    ds_read_b64_tr_b16 a[108:109], v11 offset:0
    v_lshlrev_b32 v48, 16, v24
    v_mfma_f32_16x16x32_bf16 v[108:111], a[88:91], a[24:27], v[108:111]
    v_exp_f32 v95, v95
    v_mfma_f32_16x16x32_bf16 v[108:111], a[92:95], a[28:31], v[108:111]
    s_add_u32 m0, s31, 24576
    ds_read_b64_tr_b16 a[110:111], v11 offset:4096
    v_cvt_pk_bf16_f32 v91, v94, v95
    v_mfma_f32_16x16x32_bf16 v[112:115], a[64:67], a[32:35], 0
    buffer_load_dwordx4 v18, s[12:15], s29 offen nt lds
    v_mfma_f32_16x16x32_bf16 v[112:115], a[68:71], a[36:39], v[112:115]
    v_exp_f32 v96, v96
    v_mfma_f32_16x16x32_bf16 v[112:115], a[72:75], a[40:43], v[112:115]
    ds_read_b64_tr_b16 a[112:113], v12 offset:0
    v_and_b32 v49, 0xffff0000, v24
    v_mfma_f32_16x16x32_bf16 v[112:115], a[76:79], a[44:47], v[112:115]
    v_exp_f32 v97, v97
    v_mfma_f32_16x16x32_bf16 v[116:119], a[80:83], a[32:35], 0
    ds_read_b64_tr_b16 a[114:115], v12 offset:4096
    v_cvt_pk_bf16_f32 v96, v96, v97
    v_mfma_f32_16x16x32_bf16 v[116:119], a[84:87], a[36:39], v[116:119]
    v_exp_f32 v98, v98
    v_mfma_f32_16x16x32_bf16 v[116:119], a[88:91], a[40:43], v[116:119]
    ds_read_b64_tr_b16 a[116:117], v13 offset:0
    v_lshlrev_b32 v50, 16, v25
    v_mfma_f32_16x16x32_bf16 v[116:119], a[92:95], a[44:47], v[116:119]
    v_exp_f32 v99, v99
    v_mfma_f32_16x16x32_bf16 v[120:123], a[64:67], a[48:51], 0
    ds_read_b64_tr_b16 a[118:119], v13 offset:4096
    v_cvt_pk_bf16_f32 v97, v98, v99
    v_mfma_f32_16x16x32_bf16 v[120:123], a[68:71], a[52:55], v[120:123]
    v_exp_f32 v100, v100
    v_mfma_f32_16x16x32_bf16 v[120:123], a[72:75], a[56:59], v[120:123]
    ds_read_b64_tr_b16 a[120:121], v14 offset:0
    v_and_b32 v51, 0xffff0000, v25
    v_mfma_f32_16x16x32_bf16 v[120:123], a[76:79], a[60:63], v[120:123]
    v_exp_f32 v101, v101
    v_mfma_f32_16x16x32_bf16 v[124:127], a[80:83], a[48:51], 0
    ds_read_b64_tr_b16 a[122:123], v14 offset:4096
    v_cvt_pk_bf16_f32 v98, v100, v101
    v_mfma_f32_16x16x32_bf16 v[124:127], a[84:87], a[52:55], v[124:127]
    v_exp_f32 v102, v102
    v_mfma_f32_16x16x32_bf16 v[124:127], a[88:91], a[56:59], v[124:127]
    ds_read_b64_tr_b16 a[124:125], v15 offset:0
    v_lshlrev_b32 v52, 16, v26
    v_mfma_f32_16x16x32_bf16 v[124:127], a[92:95], a[60:63], v[124:127]
    v_exp_f32 v103, v103
    v_mfma_f32_16x16x32_bf16 v[28:31], v[44:47], v[64:67], v[28:31]
    ds_read_b64_tr_b16 a[126:127], v15 offset:4096
    v_cvt_pk_bf16_f32 v99, v102, v103
    v_mfma_f32_16x16x32_bf16 v[128:131], a[96:99], v[64:67], v[128:131]
    s_waitcnt lgkmcnt(12)
    buffer_load_dwordx4 v19, s[12:15], s29 offen offset:1024 nt lds
    s_add_u32 s29, s29, 8192
    v_mfma_f32_16x16x32_bf16 v[132:135], a[100:103], v[64:67], v[132:135]
    s_waitcnt lgkmcnt(10)
    v_exp_f32 v104, v104
    v_mfma_f32_16x16x32_bf16 v[136:139], a[104:107], v[64:67], v[136:139]
    s_waitcnt lgkmcnt(8)
    ds_read_b128 a[64:67], v4 offset:16384
    v_and_b32 v53, 0xffff0000, v26
    v_mfma_f32_16x16x32_bf16 v[140:143], a[108:111], v[64:67], v[140:143]
    s_waitcnt lgkmcnt(7)
    v_exp_f32 v105, v105
    v_mfma_f32_16x16x32_bf16 v[144:147], a[112:115], v[64:67], v[144:147]
    s_waitcnt lgkmcnt(5)
    v_cvt_pk_bf16_f32 v104, v104, v105
    v_lshlrev_b32 v54, 16, v27
    v_mfma_f32_16x16x32_bf16 v[148:151], a[116:119], v[64:67], v[148:151]
    s_waitcnt lgkmcnt(3)
    v_exp_f32 v106, v106
    v_mfma_f32_16x16x32_bf16 v[152:155], a[120:123], v[64:67], v[152:155]
    s_waitcnt lgkmcnt(1)
    ds_read_b128 a[68:71], v5 offset:16384
    v_and_b32 v55, 0xffff0000, v27
    v_mfma_f32_16x16x32_bf16 v[156:159], a[124:127], v[64:67], v[156:159]
    v_exp_f32 v107, v107
    v_mfma_f32_16x16x32_bf16 v[32:35], v[44:47], v[72:75], v[32:35]
    v_cvt_pk_bf16_f32 v105, v106, v107
    v_mul_f32 v48, s34, v48
    v_mfma_f32_16x16x32_bf16 v[160:163], a[96:99], v[72:75], v[160:163]
    v_exp_f32 v108, v108
    v_mfma_f32_16x16x32_bf16 v[164:167], a[100:103], v[72:75], v[164:167]
    ds_read_b128 a[72:75], v6 offset:16384
    v_mul_f32 v49, s34, v49
    v_mfma_f32_16x16x32_bf16 v[168:171], a[104:107], v[72:75], v[168:171]
    s_add_u32 m0, s42, 1024
    v_exp_f32 v109, v109
    v_mfma_f32_16x16x32_bf16 v[172:175], a[108:111], v[72:75], v[172:175]
    buffer_load_dwordx4 v21, s[16:19], s43 offen nt lds
    v_cvt_pk_bf16_f32 v106, v108, v109
    v_mfma_f32_16x16x32_bf16 v[176:179], a[112:115], v[72:75], v[176:179]
    v_exp_f32 v110, v110
    v_mfma_f32_16x16x32_bf16 v[180:183], a[116:119], v[72:75], v[180:183]
    ds_read_b128 a[76:79], v7 offset:16384
    v_mul_f32 v50, s34, v50
    v_mfma_f32_16x16x32_bf16 v[184:187], a[120:123], v[72:75], v[184:187]
    v_exp_f32 v111, v111
    v_mfma_f32_16x16x32_bf16 v[188:191], a[124:127], v[72:75], v[188:191]
    s_xor_b32 m0, s30, 16384
    v_cvt_pk_bf16_f32 v107, v110, v111
    v_mul_f32 v51, s34, v51
    v_mfma_f32_16x16x32_bf16 v[36:39], v[44:47], v[80:83], v[36:39]
    buffer_load_dwordx4 v16, s[8:11], s28 offen nt lds
    v_mfma_f32_16x16x32_bf16 v[192:195], a[96:99], v[80:83], v[192:195]
    v_exp_f32 v112, v112
    v_mfma_f32_16x16x32_bf16 v[196:199], a[100:103], v[80:83], v[196:199]
    ds_read_b128 a[80:83], v4 offset:20480
    v_mul_f32 v52, s34, v52
    v_mfma_f32_16x16x32_bf16 v[200:203], a[104:107], v[80:83], v[200:203]
    v_exp_f32 v113, v113
    v_mfma_f32_16x16x32_bf16 v[204:207], a[108:111], v[80:83], v[204:207]
    v_cvt_pk_bf16_f32 v112, v112, v113
    v_mul_f32 v53, s34, v53
    v_mfma_f32_16x16x32_bf16 v[208:211], a[112:115], v[80:83], v[208:211]
    v_exp_f32 v114, v114
    v_mfma_f32_16x16x32_bf16 v[212:215], a[116:119], v[80:83], v[212:215]
    ds_read_b128 a[84:87], v5 offset:20480
    v_mul_f32 v54, s34, v54
    v_mfma_f32_16x16x32_bf16 v[216:219], a[120:123], v[80:83], v[216:219]
    v_exp_f32 v115, v115
    v_mfma_f32_16x16x32_bf16 v[220:223], a[124:127], v[80:83], v[220:223]
    v_cvt_pk_bf16_f32 v113, v114, v115
    v_mul_f32 v55, s34, v55
    v_mfma_f32_16x16x32_bf16 v[40:43], v[44:47], v[88:91], v[40:43]
    v_exp_f32 v116, v116
    v_mfma_f32_16x16x32_bf16 v[224:227], a[96:99], v[88:91], v[224:227]
    ds_read_b128 a[88:91], v6 offset:20480
    v_cvt_pk_bf16_f32 v24, v48, v49
    v_mfma_f32_16x16x32_bf16 v[228:231], a[100:103], v[88:91], v[228:231]
    v_exp_f32 v117, v117
    v_mfma_f32_16x16x32_bf16 v[232:235], a[104:107], v[88:91], v[232:235]
    v_cvt_pk_bf16_f32 v114, v116, v117
    v_cvt_pk_bf16_f32 v25, v50, v51
    v_mfma_f32_16x16x32_bf16 v[236:239], a[108:111], v[88:91], v[236:239]
    v_exp_f32 v118, v118
    v_mfma_f32_16x16x32_bf16 v[240:243], a[112:115], v[88:91], v[240:243]
    ds_read_b128 a[92:95], v7 offset:20480
    v_cvt_pk_bf16_f32 v26, v52, v53
    v_mfma_f32_16x16x32_bf16 v[244:247], a[116:119], v[88:91], v[244:247]
    v_exp_f32 v119, v119
    v_mfma_f32_16x16x32_bf16 v[248:251], a[120:123], v[88:91], v[248:251]
    v_cvt_pk_bf16_f32 v115, v118, v119
    v_cvt_pk_bf16_f32 v27, v54, v55
    v_mfma_f32_16x16x32_bf16 v[252:255], a[124:127], v[88:91], v[252:255]
    buffer_load_dwordx4 v17, s[8:11], s28 offen offset:1024 nt lds
    s_add_u32 s28, s28, 8192
    ds_write_b128 v3, v[24:27] offset:1024
    s_add_u32 s33, s33, 1
    s_xor_b32 s30, s30, 0x8000
    s_branch L_LOOP0
L_DRAIN0:
    s_waitcnt vmcnt(13)
    s_barrier
    v_mfma_f32_16x16x32_bf16 v[28:31], v[44:47], v[96:99], v[28:31]
    ds_read_b64_tr_b16 a[96:97], v8 offset:24576
    ds_read_b64_tr_b16 a[98:99], v8 offset:28672
    ds_read_b64_tr_b16 a[100:101], v9 offset:24576
    ds_read_b64_tr_b16 a[102:103], v9 offset:28672
    ds_read_b64_tr_b16 a[104:105], v10 offset:24576
    ds_read_b64_tr_b16 a[106:107], v10 offset:28672
    ds_read_b64_tr_b16 a[108:109], v11 offset:24576
    ds_read_b64_tr_b16 a[110:111], v11 offset:28672
    ds_read_b64_tr_b16 a[112:113], v12 offset:24576
    ds_read_b64_tr_b16 a[114:115], v12 offset:28672
    ds_read_b64_tr_b16 a[116:117], v13 offset:24576
    ds_read_b64_tr_b16 a[118:119], v13 offset:28672
    ds_read_b64_tr_b16 a[120:121], v14 offset:24576
    ds_read_b64_tr_b16 a[122:123], v14 offset:28672
    ds_read_b64_tr_b16 a[124:125], v15 offset:24576
    ds_read_b64_tr_b16 a[126:127], v15 offset:28672
    v_add_u32 v24, s45, v4
    v_add_u32 v25, s45, v5
    v_add_u32 v26, s45, v6
    v_add_u32 v27, s45, v7
    v_exp_f32 v120, v120
    v_exp_f32 v121, v121
    v_exp_f32 v122, v122
    v_cvt_pk_bf16_f32 v120, v120, v121
    v_exp_f32 v123, v123
    v_exp_f32 v124, v124
    v_cvt_pk_bf16_f32 v121, v122, v123
    v_exp_f32 v125, v125
    v_exp_f32 v126, v126
    v_cvt_pk_bf16_f32 v122, v124, v125
    v_exp_f32 v127, v127
    s_nop 0
    v_cvt_pk_bf16_f32 v123, v126, v127
    s_waitcnt lgkmcnt(14)
    v_mfma_f32_16x16x32_bf16 v[128:131], a[96:99], v[96:99], v[128:131]
    ds_read_b128 a[0:3], v24 offset:0
    ds_read_b128 a[4:7], v25 offset:0
    ds_read_b128 a[8:11], v26 offset:0
    ds_read_b128 a[12:15], v27 offset:0
    s_waitcnt lgkmcnt(15)
    v_mfma_f32_16x16x32_bf16 v[132:135], a[100:103], v[96:99], v[132:135]
    ds_read_b128 a[16:19], v24 offset:4096
    ds_read_b128 a[20:23], v25 offset:4096
    ds_read_b128 a[24:27], v26 offset:4096
    ds_read_b128 a[28:31], v27 offset:4096
    s_waitcnt lgkmcnt(15)
    v_mfma_f32_16x16x32_bf16 v[136:139], a[104:107], v[96:99], v[136:139]
    ds_read_b128 a[32:35], v24 offset:8192
    ds_read_b128 a[36:39], v25 offset:8192
    ds_read_b128 a[40:43], v26 offset:8192
    ds_read_b128 a[44:47], v27 offset:8192
    v_mfma_f32_16x16x32_bf16 v[140:143], a[108:111], v[96:99], v[140:143]
    s_add_u32 m0, s31, 16384
    s_nop 0
    buffer_load_dwordx4 v18, s[12:15], s29 offen nt lds
    buffer_load_dwordx4 v19, s[12:15], s29 offen offset:1024 nt lds
    s_waitcnt lgkmcnt(15)
    v_mfma_f32_16x16x32_bf16 v[144:147], a[112:115], v[96:99], v[144:147]
    s_add_u32 s29, s29, 8192
    s_add_u32 m0, s44, 40960
    s_nop 0
    buffer_load_dwordx4 v16, s[8:11], s28 offen nt lds
    buffer_load_dwordx4 v17, s[8:11], s28 offen offset:1024 nt lds
    v_mfma_f32_16x16x32_bf16 v[148:151], a[116:119], v[96:99], v[148:151]
    s_add_u32 s28, s28, 8192
    v_and_b32 v57, 15, v0
    v_bfe_u32 v56, v0, 5, 1
    v_bfe_u32 v58, v0, 4, 1
    v_xor_b32 v56, v56, v57
    s_waitcnt lgkmcnt(14)
    v_mfma_f32_16x16x32_bf16 v[152:155], a[120:123], v[96:99], v[152:155]
    v_lshlrev_b32 v56, 4, v56
    v_lshl_add_u32 v56, v58, 3, v56
    v_lshl_add_u32 v56, v57, 8, v56
    v_add_u32 v56, s45, v56
    s_waitcnt lgkmcnt(12)
    v_mfma_f32_16x16x32_bf16 v[156:159], a[124:127], v[96:99], v[156:159]
    v_xor_b32 v63, 224, v56
    v_xor_b32 v62, 192, v56
    v_xor_b32 v61, 160, v56
    v_xor_b32 v60, 128, v56
    v_mfma_f32_16x16x32_bf16 v[32:35], v[44:47], v[104:107], v[32:35]
    v_xor_b32 v59, 96, v56
    v_xor_b32 v58, 64, v56
    v_xor_b32 v57, 32, v56
    v_mfma_f32_16x16x32_bf16 v[160:163], a[96:99], v[104:107], v[160:163]
    v_mfma_f32_16x16x32_bf16 v[164:167], a[100:103], v[104:107], v[164:167]
    v_rcp_f32 v30, v28
    s_nop 0
    v_pk_mul_f32 v[128:129], v[128:129], v[30:31] op_sel_hi:[1,0]
    v_pk_mul_f32 v[130:131], v[130:131], v[30:31] op_sel_hi:[1,0]
    v_pk_mul_f32 v[132:133], v[132:133], v[30:31] op_sel_hi:[1,0]
    v_pk_mul_f32 v[134:135], v[134:135], v[30:31] op_sel_hi:[1,0]
    v_mfma_f32_16x16x32_bf16 v[168:171], a[104:107], v[104:107], v[168:171]
    v_cvt_pk_bf16_f32 v128, v128, v129
    v_cvt_pk_bf16_f32 v129, v130, v131
    v_cvt_pk_bf16_f32 v132, v132, v133
    v_cvt_pk_bf16_f32 v133, v134, v135
    v_pk_mul_f32 v[136:137], v[136:137], v[30:31] op_sel_hi:[1,0]
    v_pk_mul_f32 v[138:139], v[138:139], v[30:31] op_sel_hi:[1,0]
    v_pk_mul_f32 v[140:141], v[140:141], v[30:31] op_sel_hi:[1,0]
    v_pk_mul_f32 v[142:143], v[142:143], v[30:31] op_sel_hi:[1,0]
    v_mfma_f32_16x16x32_bf16 v[172:175], a[108:111], v[104:107], v[172:175]
    ds_write_b64 v56, v[128:129] offset:0
    ds_write_b64 v57, v[132:133] offset:0
    v_cvt_pk_bf16_f32 v136, v136, v137
    v_cvt_pk_bf16_f32 v137, v138, v139
    v_cvt_pk_bf16_f32 v140, v140, v141
    v_cvt_pk_bf16_f32 v141, v142, v143
    v_pk_mul_f32 v[144:145], v[144:145], v[30:31] op_sel_hi:[1,0]
    v_pk_mul_f32 v[146:147], v[146:147], v[30:31] op_sel_hi:[1,0]
    v_pk_mul_f32 v[148:149], v[148:149], v[30:31] op_sel_hi:[1,0]
    v_pk_mul_f32 v[150:151], v[150:151], v[30:31] op_sel_hi:[1,0]
    v_mfma_f32_16x16x32_bf16 v[176:179], a[112:115], v[104:107], v[176:179]
    ds_write_b64 v58, v[136:137] offset:0
    ds_write_b64 v59, v[140:141] offset:0
    v_cvt_pk_bf16_f32 v144, v144, v145
    v_cvt_pk_bf16_f32 v145, v146, v147
    v_cvt_pk_bf16_f32 v148, v148, v149
    v_cvt_pk_bf16_f32 v149, v150, v151
    v_pk_mul_f32 v[152:153], v[152:153], v[30:31] op_sel_hi:[1,0]
    v_pk_mul_f32 v[154:155], v[154:155], v[30:31] op_sel_hi:[1,0]
    v_pk_mul_f32 v[156:157], v[156:157], v[30:31] op_sel_hi:[1,0]
    v_pk_mul_f32 v[158:159], v[158:159], v[30:31] op_sel_hi:[1,0]
    v_mfma_f32_16x16x32_bf16 v[180:183], a[116:119], v[104:107], v[180:183]
    ds_write_b64 v60, v[144:145] offset:0
    ds_write_b64 v61, v[148:149] offset:0
    v_cvt_pk_bf16_f32 v152, v152, v153
    v_cvt_pk_bf16_f32 v153, v154, v155
    v_cvt_pk_bf16_f32 v156, v156, v157
    v_cvt_pk_bf16_f32 v157, v158, v159
    v_mfma_f32_16x16x32_bf16 v[184:187], a[120:123], v[104:107], v[184:187]
    ds_write_b64 v62, v[152:153] offset:0
    ds_write_b64 v63, v[156:157] offset:0
    v_mfma_f32_16x16x32_bf16 v[188:191], a[124:127], v[104:107], v[188:191]
    v_mfma_f32_16x16x32_bf16 v[36:39], v[44:47], v[112:115], v[36:39]
    v_mfma_f32_16x16x32_bf16 v[192:195], a[96:99], v[112:115], v[192:195]
    v_mfma_f32_16x16x32_bf16 v[196:199], a[100:103], v[112:115], v[196:199]
    v_rcp_f32 v34, v32
    s_nop 0
    v_pk_mul_f32 v[160:161], v[160:161], v[34:35] op_sel_hi:[1,0]
    v_pk_mul_f32 v[162:163], v[162:163], v[34:35] op_sel_hi:[1,0]
    v_pk_mul_f32 v[164:165], v[164:165], v[34:35] op_sel_hi:[1,0]
    v_pk_mul_f32 v[166:167], v[166:167], v[34:35] op_sel_hi:[1,0]
    v_mfma_f32_16x16x32_bf16 v[200:203], a[104:107], v[112:115], v[200:203]
    v_cvt_pk_bf16_f32 v160, v160, v161
    v_cvt_pk_bf16_f32 v161, v162, v163
    v_cvt_pk_bf16_f32 v164, v164, v165
    v_cvt_pk_bf16_f32 v165, v166, v167
    v_mfma_f32_16x16x32_bf16 v[204:207], a[108:111], v[112:115], v[204:207]
    s_waitcnt vmcnt(6)
    ds_read_b128 v[88:91], v24 offset:12288
    ds_read_b128 v[92:95], v25 offset:12288
    s_waitcnt lgkmcnt(1)
    v_lshlrev_b32 v48, 16, v88
    v_and_b32 v49, 0xffff0000, v88
    v_mfma_f32_16x16x32_bf16 v[208:211], a[112:115], v[112:115], v[208:211]
    v_lshlrev_b32 v50, 16, v89
    v_and_b32 v51, 0xffff0000, v89
    v_lshlrev_b32 v52, 16, v90
    v_and_b32 v53, 0xffff0000, v90
    v_mfma_f32_16x16x32_bf16 v[212:215], a[116:119], v[112:115], v[212:215]
    v_lshlrev_b32 v54, 16, v91
    v_and_b32 v55, 0xffff0000, v91
    v_pk_mul_f32 v[168:169], v[168:169], v[34:35] op_sel_hi:[1,0]
    v_pk_mul_f32 v[170:171], v[170:171], v[34:35] op_sel_hi:[1,0]
    v_pk_mul_f32 v[172:173], v[172:173], v[34:35] op_sel_hi:[1,0]
    v_pk_mul_f32 v[174:175], v[174:175], v[34:35] op_sel_hi:[1,0]
    v_mfma_f32_16x16x32_bf16 v[216:219], a[120:123], v[112:115], v[216:219]
    ds_write_b64 v56, v[160:161] offset:4096
    ds_write_b64 v57, v[164:165] offset:4096
    v_cvt_pk_bf16_f32 v168, v168, v169
    v_cvt_pk_bf16_f32 v169, v170, v171
    v_cvt_pk_bf16_f32 v172, v172, v173
    v_cvt_pk_bf16_f32 v173, v174, v175
    v_mfma_f32_16x16x32_bf16 v[220:223], a[124:127], v[112:115], v[220:223]
    v_mul_f32 v48, s34, v48
    v_mul_f32 v49, s34, v49
    v_mul_f32 v50, s34, v50
    v_mul_f32 v51, s34, v51
    v_mfma_f32_16x16x32_bf16 v[40:43], v[44:47], v[120:123], v[40:43]
    v_mul_f32 v52, s34, v52
    v_mul_f32 v53, s34, v53
    v_mul_f32 v54, s34, v54
    v_mul_f32 v55, s34, v55
    v_mfma_f32_16x16x32_bf16 v[224:227], a[96:99], v[120:123], v[224:227]
    v_cvt_pk_bf16_f32 v88, v48, v49
    v_cvt_pk_bf16_f32 v89, v50, v51
    v_cvt_pk_bf16_f32 v90, v52, v53
    v_cvt_pk_bf16_f32 v91, v54, v55
    v_mfma_f32_16x16x32_bf16 v[228:231], a[100:103], v[120:123], v[228:231]
    v_accvgpr_write_b32 a48, v88
    v_accvgpr_write_b32 a49, v89
    v_accvgpr_write_b32 a50, v90
    v_accvgpr_write_b32 a51, v91
    v_pk_mul_f32 v[176:177], v[176:177], v[34:35] op_sel_hi:[1,0]
    v_pk_mul_f32 v[178:179], v[178:179], v[34:35] op_sel_hi:[1,0]
    v_pk_mul_f32 v[180:181], v[180:181], v[34:35] op_sel_hi:[1,0]
    v_pk_mul_f32 v[182:183], v[182:183], v[34:35] op_sel_hi:[1,0]
    v_mfma_f32_16x16x32_bf16 v[232:235], a[104:107], v[120:123], v[232:235]
    ds_write_b64 v58, v[168:169] offset:4096
    ds_write_b64 v59, v[172:173] offset:4096
    v_cvt_pk_bf16_f32 v176, v176, v177
    v_cvt_pk_bf16_f32 v177, v178, v179
    v_cvt_pk_bf16_f32 v180, v180, v181
    v_cvt_pk_bf16_f32 v181, v182, v183
    v_mfma_f32_16x16x32_bf16 v[236:239], a[108:111], v[120:123], v[236:239]
    s_waitcnt lgkmcnt(4)
    v_lshlrev_b32 v48, 16, v92
    v_and_b32 v49, 0xffff0000, v92
    v_lshlrev_b32 v50, 16, v93
    v_and_b32 v51, 0xffff0000, v93
    v_mfma_f32_16x16x32_bf16 v[240:243], a[112:115], v[120:123], v[240:243]
    v_lshlrev_b32 v52, 16, v94
    v_and_b32 v53, 0xffff0000, v94
    v_lshlrev_b32 v54, 16, v95
    v_and_b32 v55, 0xffff0000, v95
    v_pk_mul_f32 v[184:185], v[184:185], v[34:35] op_sel_hi:[1,0]
    v_pk_mul_f32 v[186:187], v[186:187], v[34:35] op_sel_hi:[1,0]
    v_pk_mul_f32 v[188:189], v[188:189], v[34:35] op_sel_hi:[1,0]
    v_pk_mul_f32 v[190:191], v[190:191], v[34:35] op_sel_hi:[1,0]
    v_mfma_f32_16x16x32_bf16 v[244:247], a[116:119], v[120:123], v[244:247]
    ds_write_b64 v60, v[176:177] offset:4096
    ds_write_b64 v61, v[180:181] offset:4096
    v_cvt_pk_bf16_f32 v184, v184, v185
    v_cvt_pk_bf16_f32 v185, v186, v187
    v_cvt_pk_bf16_f32 v188, v188, v189
    v_cvt_pk_bf16_f32 v189, v190, v191
    v_mfma_f32_16x16x32_bf16 v[248:251], a[120:123], v[120:123], v[248:251]
    v_mul_f32 v48, s34, v48
    v_mul_f32 v49, s34, v49
    v_mul_f32 v50, s34, v50
    v_mul_f32 v51, s34, v51
    v_mfma_f32_16x16x32_bf16 v[252:255], a[124:127], v[120:123], v[252:255]
    v_mul_f32 v52, s34, v52
    v_mul_f32 v53, s34, v53
    v_mul_f32 v54, s34, v54
    v_mul_f32 v55, s34, v55
    v_mfma_f32_16x16x32_bf16 v[64:67], a[64:67], a[0:3], 0
    v_cvt_pk_bf16_f32 v92, v48, v49
    v_cvt_pk_bf16_f32 v93, v50, v51
    v_cvt_pk_bf16_f32 v94, v52, v53
    v_cvt_pk_bf16_f32 v95, v54, v55
    v_mfma_f32_16x16x32_bf16 v[64:67], a[68:71], a[4:7], v[64:67]
    v_accvgpr_write_b32 a52, v92
    v_accvgpr_write_b32 a53, v93
    v_accvgpr_write_b32 a54, v94
    v_accvgpr_write_b32 a55, v95
    v_mfma_f32_16x16x32_bf16 v[64:67], a[72:75], a[8:11], v[64:67]
    ds_write_b64 v62, v[184:185] offset:4096
    ds_write_b64 v63, v[188:189] offset:4096
    ds_read_b128 v[88:91], v26 offset:12288
    v_mfma_f32_16x16x32_bf16 v[64:67], a[76:79], a[12:15], v[64:67]
    ds_read_b128 v[92:95], v27 offset:12288
    s_waitcnt lgkmcnt(1)
    v_lshlrev_b32 v48, 16, v88
    v_and_b32 v49, 0xffff0000, v88
    v_lshlrev_b32 v50, 16, v89
    v_mfma_f32_16x16x32_bf16 v[68:71], a[80:83], a[0:3], 0
    v_and_b32 v51, 0xffff0000, v89
    v_lshlrev_b32 v52, 16, v90
    v_and_b32 v53, 0xffff0000, v90
    v_lshlrev_b32 v54, 16, v91
    v_mfma_f32_16x16x32_bf16 v[68:71], a[84:87], a[4:7], v[68:71]
    v_and_b32 v55, 0xffff0000, v91
    v_rcp_f32 v38, v36
    s_nop 0
    v_pk_mul_f32 v[192:193], v[192:193], v[38:39] op_sel_hi:[1,0]
    v_pk_mul_f32 v[194:195], v[194:195], v[38:39] op_sel_hi:[1,0]
    v_pk_mul_f32 v[196:197], v[196:197], v[38:39] op_sel_hi:[1,0]
    v_pk_mul_f32 v[198:199], v[198:199], v[38:39] op_sel_hi:[1,0]
    v_mfma_f32_16x16x32_bf16 v[68:71], a[88:91], a[8:11], v[68:71]
    v_cvt_pk_bf16_f32 v192, v192, v193
    v_cvt_pk_bf16_f32 v193, v194, v195
    v_cvt_pk_bf16_f32 v196, v196, v197
    v_cvt_pk_bf16_f32 v197, v198, v199
    v_mfma_f32_16x16x32_bf16 v[68:71], a[92:95], a[12:15], v[68:71]
    v_mul_f32 v48, s34, v48
    v_mul_f32 v49, s34, v49
    v_mul_f32 v50, s34, v50
    v_mul_f32 v51, s34, v51
    v_mfma_f32_16x16x32_bf16 v[72:75], a[64:67], a[16:19], 0
    v_mul_f32 v52, s34, v52
    v_mul_f32 v53, s34, v53
    v_mul_f32 v54, s34, v54
    v_mul_f32 v55, s34, v55
    v_mfma_f32_16x16x32_bf16 v[72:75], a[68:71], a[20:23], v[72:75]
    v_cvt_pk_bf16_f32 v88, v48, v49
    v_cvt_pk_bf16_f32 v89, v50, v51
    v_cvt_pk_bf16_f32 v90, v52, v53
    v_cvt_pk_bf16_f32 v91, v54, v55
    v_mfma_f32_16x16x32_bf16 v[72:75], a[72:75], a[24:27], v[72:75]
    v_accvgpr_write_b32 a56, v88
    v_accvgpr_write_b32 a57, v89
    v_accvgpr_write_b32 a58, v90
    v_accvgpr_write_b32 a59, v91
    v_pk_mul_f32 v[200:201], v[200:201], v[38:39] op_sel_hi:[1,0]
    v_pk_mul_f32 v[202:203], v[202:203], v[38:39] op_sel_hi:[1,0]
    v_pk_mul_f32 v[204:205], v[204:205], v[38:39] op_sel_hi:[1,0]
    v_pk_mul_f32 v[206:207], v[206:207], v[38:39] op_sel_hi:[1,0]
    v_mfma_f32_16x16x32_bf16 v[72:75], a[76:79], a[28:31], v[72:75]
    ds_write_b64 v56, v[192:193] offset:8192
    ds_write_b64 v57, v[196:197] offset:8192
    v_cvt_pk_bf16_f32 v200, v200, v201
    v_cvt_pk_bf16_f32 v201, v202, v203
    v_cvt_pk_bf16_f32 v204, v204, v205
    v_cvt_pk_bf16_f32 v205, v206, v207
    v_mfma_f32_16x16x32_bf16 v[76:79], a[80:83], a[16:19], 0
    s_waitcnt lgkmcnt(2)
    v_lshlrev_b32 v48, 16, v92
    v_and_b32 v49, 0xffff0000, v92
    v_lshlrev_b32 v50, 16, v93
    v_and_b32 v51, 0xffff0000, v93
    v_mfma_f32_16x16x32_bf16 v[76:79], a[84:87], a[20:23], v[76:79]
    v_lshlrev_b32 v52, 16, v94
    v_and_b32 v53, 0xffff0000, v94
    v_lshlrev_b32 v54, 16, v95
    v_and_b32 v55, 0xffff0000, v95
    v_pk_mul_f32 v[208:209], v[208:209], v[38:39] op_sel_hi:[1,0]
    v_pk_mul_f32 v[210:211], v[210:211], v[38:39] op_sel_hi:[1,0]
    v_pk_mul_f32 v[212:213], v[212:213], v[38:39] op_sel_hi:[1,0]
    v_pk_mul_f32 v[214:215], v[214:215], v[38:39] op_sel_hi:[1,0]
    v_mfma_f32_16x16x32_bf16 v[76:79], a[88:91], a[24:27], v[76:79]
    ds_write_b64 v58, v[200:201] offset:8192
    ds_write_b64 v59, v[204:205] offset:8192
    v_cvt_pk_bf16_f32 v208, v208, v209
    v_cvt_pk_bf16_f32 v209, v210, v211
    v_cvt_pk_bf16_f32 v212, v212, v213
    v_cvt_pk_bf16_f32 v213, v214, v215
    v_mfma_f32_16x16x32_bf16 v[76:79], a[92:95], a[28:31], v[76:79]
    v_mul_f32 v48, s34, v48
    v_mul_f32 v49, s34, v49
    v_mul_f32 v50, s34, v50
    v_mul_f32 v51, s34, v51
    v_mfma_f32_16x16x32_bf16 v[80:83], a[64:67], a[32:35], 0
    v_mul_f32 v52, s34, v52
    v_mul_f32 v53, s34, v53
    v_mul_f32 v54, s34, v54
    v_mul_f32 v55, s34, v55
    v_mfma_f32_16x16x32_bf16 v[80:83], a[68:71], a[36:39], v[80:83]
    v_cvt_pk_bf16_f32 v92, v48, v49
    v_cvt_pk_bf16_f32 v93, v50, v51
    v_cvt_pk_bf16_f32 v94, v52, v53
    v_cvt_pk_bf16_f32 v95, v54, v55
    v_mfma_f32_16x16x32_bf16 v[80:83], a[72:75], a[40:43], v[80:83]
    v_accvgpr_write_b32 a60, v92
    v_accvgpr_write_b32 a61, v93
    v_accvgpr_write_b32 a62, v94
    v_accvgpr_write_b32 a63, v95
    v_pk_mul_f32 v[216:217], v[216:217], v[38:39] op_sel_hi:[1,0]
    v_pk_mul_f32 v[218:219], v[218:219], v[38:39] op_sel_hi:[1,0]
    v_pk_mul_f32 v[220:221], v[220:221], v[38:39] op_sel_hi:[1,0]
    v_pk_mul_f32 v[222:223], v[222:223], v[38:39] op_sel_hi:[1,0]
    v_mfma_f32_16x16x32_bf16 v[80:83], a[76:79], a[44:47], v[80:83]
    ds_write_b64 v60, v[208:209] offset:8192
    ds_write_b64 v61, v[212:213] offset:8192
    v_cvt_pk_bf16_f32 v216, v216, v217
    v_cvt_pk_bf16_f32 v217, v218, v219
    v_cvt_pk_bf16_f32 v220, v220, v221
    v_cvt_pk_bf16_f32 v221, v222, v223
    v_mfma_f32_16x16x32_bf16 v[84:87], a[80:83], a[32:35], 0
    ds_write_b64 v62, v[216:217] offset:8192
    ds_write_b64 v63, v[220:221] offset:8192
    v_rcp_f32 v42, v40
    s_nop 0
    v_pk_mul_f32 v[224:225], v[224:225], v[42:43] op_sel_hi:[1,0]
    v_pk_mul_f32 v[226:227], v[226:227], v[42:43] op_sel_hi:[1,0]
    v_pk_mul_f32 v[228:229], v[228:229], v[42:43] op_sel_hi:[1,0]
    v_pk_mul_f32 v[230:231], v[230:231], v[42:43] op_sel_hi:[1,0]
    v_mfma_f32_16x16x32_bf16 v[84:87], a[84:87], a[36:39], v[84:87]
    v_cvt_pk_bf16_f32 v224, v224, v225
    v_cvt_pk_bf16_f32 v225, v226, v227
    v_cvt_pk_bf16_f32 v228, v228, v229
    v_cvt_pk_bf16_f32 v229, v230, v231
    v_pk_mul_f32 v[232:233], v[232:233], v[42:43] op_sel_hi:[1,0]
    v_pk_mul_f32 v[234:235], v[234:235], v[42:43] op_sel_hi:[1,0]
    v_pk_mul_f32 v[236:237], v[236:237], v[42:43] op_sel_hi:[1,0]
    v_pk_mul_f32 v[238:239], v[238:239], v[42:43] op_sel_hi:[1,0]
    v_mfma_f32_16x16x32_bf16 v[84:87], a[88:91], a[40:43], v[84:87]
    ds_write_b64 v56, v[224:225] offset:12288
    ds_write_b64 v57, v[228:229] offset:12288
    v_cvt_pk_bf16_f32 v232, v232, v233
    v_cvt_pk_bf16_f32 v233, v234, v235
    v_cvt_pk_bf16_f32 v236, v236, v237
    v_cvt_pk_bf16_f32 v237, v238, v239
    v_pk_mul_f32 v[240:241], v[240:241], v[42:43] op_sel_hi:[1,0]
    v_pk_mul_f32 v[242:243], v[242:243], v[42:43] op_sel_hi:[1,0]
    v_pk_mul_f32 v[244:245], v[244:245], v[42:43] op_sel_hi:[1,0]
    v_pk_mul_f32 v[246:247], v[246:247], v[42:43] op_sel_hi:[1,0]
    v_mfma_f32_16x16x32_bf16 v[84:87], a[92:95], a[44:47], v[84:87]
    ds_write_b64 v58, v[232:233] offset:12288
    ds_write_b64 v59, v[236:237] offset:12288
    v_cvt_pk_bf16_f32 v240, v240, v241
    v_cvt_pk_bf16_f32 v241, v242, v243
    v_cvt_pk_bf16_f32 v244, v244, v245
    v_cvt_pk_bf16_f32 v245, v246, v247
    v_pk_mul_f32 v[248:249], v[248:249], v[42:43] op_sel_hi:[1,0]
    v_pk_mul_f32 v[250:251], v[250:251], v[42:43] op_sel_hi:[1,0]
    v_pk_mul_f32 v[252:253], v[252:253], v[42:43] op_sel_hi:[1,0]
    v_pk_mul_f32 v[254:255], v[254:255], v[42:43] op_sel_hi:[1,0]
    v_mfma_f32_16x16x32_bf16 v[88:91], a[64:67], a[48:51], 0
    ds_write_b64 v60, v[240:241] offset:12288
    ds_write_b64 v61, v[244:245] offset:12288
    v_cvt_pk_bf16_f32 v248, v248, v249
    v_cvt_pk_bf16_f32 v249, v250, v251
    v_cvt_pk_bf16_f32 v252, v252, v253
    v_cvt_pk_bf16_f32 v253, v254, v255
    v_mfma_f32_16x16x32_bf16 v[88:91], a[68:71], a[52:55], v[88:91]
    ds_write_b64 v62, v[248:249] offset:12288
    ds_write_b64 v63, v[252:253] offset:12288
    v_min3_f32 v24, v28, v32, v36
    v_mfma_f32_16x16x32_bf16 v[88:91], a[72:75], a[56:59], v[88:91]
    v_add_f32 v25, v28, v32
    v_add_f32 v26, v36, v40
    v_min_f32 v24, v24, v40
    v_add_f32 v25, v25, v26
    v_mfma_f32_16x16x32_bf16 v[88:91], a[76:79], a[60:63], v[88:91]
    v_cmp_le_f32 vcc, 0x30800000, v24
    s_mov_b64 s[46:47], vcc
    v_cmp_ge_f32 vcc, 0x54800000, v25
    s_and_b64 s[46:47], s[46:47], vcc
    s_cmp_eq_u64 s[46:47], -1
    s_cselect_b32 s46, 0, 1
    v_mfma_f32_16x16x32_bf16 v[92:95], a[80:83], a[48:51], 0
    s_or_b32 s37, s37, s46
    v_exp_f32 v64, v64
    v_exp_f32 v65, v65
    v_mfma_f32_16x16x32_bf16 v[92:95], a[84:87], a[52:55], v[92:95]
    v_exp_f32 v66, v66
    v_cvt_pk_bf16_f32 v64, v64, v65
    v_exp_f32 v67, v67
    v_mfma_f32_16x16x32_bf16 v[92:95], a[88:91], a[56:59], v[92:95]
    v_exp_f32 v68, v68
    v_cvt_pk_bf16_f32 v65, v66, v67
    v_exp_f32 v69, v69
    v_mfma_f32_16x16x32_bf16 v[92:95], a[92:95], a[60:63], v[92:95]
    v_exp_f32 v70, v70
    v_cvt_pk_bf16_f32 v66, v68, v69
    v_exp_f32 v71, v71
    s_nop 0
    v_cvt_pk_bf16_f32 v67, v70, v71
    v_exp_f32 v72, v72
    v_exp_f32 v73, v73
    v_exp_f32 v74, v74
    v_cvt_pk_bf16_f32 v72, v72, v73
    v_exp_f32 v75, v75
    v_exp_f32 v76, v76
    v_cvt_pk_bf16_f32 v73, v74, v75
    v_exp_f32 v77, v77
    v_exp_f32 v78, v78
    v_cvt_pk_bf16_f32 v74, v76, v77
    v_exp_f32 v79, v79
    s_nop 0
    v_cvt_pk_bf16_f32 v75, v78, v79
    ds_read_b128 a[64:67], v4 offset:8192
    ds_read_b128 a[68:71], v5 offset:8192
    ds_read_b128 a[72:75], v6 offset:8192
    ds_read_b128 a[76:79], v7 offset:8192
    ds_read_b128 a[80:83], v4 offset:12288
    ds_read_b128 a[84:87], v5 offset:12288
    ds_read_b128 a[88:91], v6 offset:12288
    ds_read_b128 a[92:95], v7 offset:12288
    v_exp_f32 v80, v80
    v_exp_f32 v81, v81
    v_exp_f32 v82, v82
    v_cvt_pk_bf16_f32 v80, v80, v81
    v_exp_f32 v83, v83
    v_exp_f32 v84, v84
    v_cvt_pk_bf16_f32 v81, v82, v83
    v_exp_f32 v85, v85
    v_exp_f32 v86, v86
    v_cvt_pk_bf16_f32 v82, v84, v85
    v_exp_f32 v87, v87
    s_nop 0
    v_cvt_pk_bf16_f32 v83, v86, v87
    s_mov_b32 s43, 0
    s_waitcnt lgkmcnt(7)
    v_mfma_f32_16x16x32_bf16 v[96:99], a[64:67], a[0:3], 0
    s_waitcnt vmcnt(12)
    s_barrier
    s_waitcnt lgkmcnt(6)
    v_exp_f32 v88, v88
    v_mfma_f32_16x16x32_bf16 v[96:99], a[68:71], a[4:7], v[96:99]
    s_waitcnt lgkmcnt(5)
    ds_read_b64_tr_b16 a[96:97], v8 offset:0
    v_mfma_f32_16x16x32_bf16 v[96:99], a[72:75], a[8:11], v[96:99]
    s_waitcnt lgkmcnt(5)
    v_exp_f32 v89, v89
    v_mfma_f32_16x16x32_bf16 v[96:99], a[76:79], a[12:15], v[96:99]
    s_waitcnt lgkmcnt(4)
    ds_read_b64_tr_b16 a[98:99], v8 offset:4096
    v_cvt_pk_bf16_f32 v88, v88, v89
    v_mfma_f32_16x16x32_bf16 v[100:103], a[80:83], a[0:3], 0
    s_waitcnt lgkmcnt(4)
    v_exp_f32 v90, v90
    v_mfma_f32_16x16x32_bf16 v[100:103], a[84:87], a[4:7], v[100:103]
    s_waitcnt lgkmcnt(3)
    ds_read_b64_tr_b16 a[100:101], v9 offset:0
    v_mfma_f32_16x16x32_bf16 v[100:103], a[88:91], a[8:11], v[100:103]
    s_waitcnt lgkmcnt(3)
    v_exp_f32 v91, v91
    v_mfma_f32_16x16x32_bf16 v[100:103], a[92:95], a[12:15], v[100:103]
    ds_read_b64_tr_b16 a[102:103], v9 offset:4096
    v_cvt_pk_bf16_f32 v89, v90, v91
    v_mfma_f32_16x16x32_bf16 v[104:107], a[64:67], a[16:19], 0
    v_exp_f32 v92, v92
    v_mfma_f32_16x16x32_bf16 v[104:107], a[68:71], a[20:23], v[104:107]
    ds_read_b64_tr_b16 a[104:105], v10 offset:0
    v_mfma_f32_16x16x32_bf16 v[104:107], a[72:75], a[24:27], v[104:107]
    v_exp_f32 v93, v93
    v_mfma_f32_16x16x32_bf16 v[104:107], a[76:79], a[28:31], v[104:107]
    ds_read_b64_tr_b16 a[106:107], v10 offset:4096
    v_cvt_pk_bf16_f32 v90, v92, v93
    v_mfma_f32_16x16x32_bf16 v[108:111], a[80:83], a[16:19], 0
    v_exp_f32 v94, v94
    v_mfma_f32_16x16x32_bf16 v[108:111], a[84:87], a[20:23], v[108:111]
    ds_read_b64_tr_b16 a[108:109], v11 offset:0
    v_mfma_f32_16x16x32_bf16 v[108:111], a[88:91], a[24:27], v[108:111]
    v_exp_f32 v95, v95
    v_mfma_f32_16x16x32_bf16 v[108:111], a[92:95], a[28:31], v[108:111]
    s_add_u32 m0, s31, 24576
    ds_read_b64_tr_b16 a[110:111], v11 offset:4096
    v_cvt_pk_bf16_f32 v91, v94, v95
    v_mfma_f32_16x16x32_bf16 v[112:115], a[64:67], a[32:35], 0
    buffer_load_dwordx4 v18, s[12:15], s29 offen nt lds
    v_mfma_f32_16x16x32_bf16 v[112:115], a[68:71], a[36:39], v[112:115]
    v_exp_f32 v96, v96
    v_mfma_f32_16x16x32_bf16 v[112:115], a[72:75], a[40:43], v[112:115]
    ds_read_b64_tr_b16 a[112:113], v12 offset:0
    v_mfma_f32_16x16x32_bf16 v[112:115], a[76:79], a[44:47], v[112:115]
    v_exp_f32 v97, v97
    v_mfma_f32_16x16x32_bf16 v[116:119], a[80:83], a[32:35], 0
    ds_read_b64_tr_b16 a[114:115], v12 offset:4096
    v_cvt_pk_bf16_f32 v96, v96, v97
    v_mfma_f32_16x16x32_bf16 v[116:119], a[84:87], a[36:39], v[116:119]
    v_exp_f32 v98, v98
    v_mfma_f32_16x16x32_bf16 v[116:119], a[88:91], a[40:43], v[116:119]
    ds_read_b64_tr_b16 a[116:117], v13 offset:0
    v_mfma_f32_16x16x32_bf16 v[116:119], a[92:95], a[44:47], v[116:119]
    v_exp_f32 v99, v99
    v_mfma_f32_16x16x32_bf16 v[120:123], a[64:67], a[48:51], 0
    ds_read_b64_tr_b16 a[118:119], v13 offset:4096
    v_cvt_pk_bf16_f32 v97, v98, v99
    v_mfma_f32_16x16x32_bf16 v[120:123], a[68:71], a[52:55], v[120:123]
    v_exp_f32 v100, v100
    v_mfma_f32_16x16x32_bf16 v[120:123], a[72:75], a[56:59], v[120:123]
    ds_read_b64_tr_b16 a[120:121], v14 offset:0
    v_mfma_f32_16x16x32_bf16 v[120:123], a[76:79], a[60:63], v[120:123]
    v_exp_f32 v101, v101
    v_mfma_f32_16x16x32_bf16 v[124:127], a[80:83], a[48:51], 0
    ds_read_b64_tr_b16 a[122:123], v14 offset:4096
    v_cvt_pk_bf16_f32 v98, v100, v101
    v_mfma_f32_16x16x32_bf16 v[124:127], a[84:87], a[52:55], v[124:127]
    v_exp_f32 v102, v102
    v_mfma_f32_16x16x32_bf16 v[124:127], a[88:91], a[56:59], v[124:127]
    ds_read_b64_tr_b16 a[124:125], v15 offset:0
    v_mfma_f32_16x16x32_bf16 v[124:127], a[92:95], a[60:63], v[124:127]
    v_exp_f32 v103, v103
    v_mfma_f32_16x16x32_bf16 v[28:31], v[44:47], v[64:67], 0
    s_waitcnt lgkmcnt(13)
    ds_read_b64_tr_b16 a[126:127], v15 offset:4096
    v_cvt_pk_bf16_f32 v99, v102, v103
    v_mfma_f32_16x16x32_bf16 v[128:131], a[96:99], v[64:67], 0
    s_waitcnt lgkmcnt(12)
    buffer_load_dwordx4 v19, s[12:15], s29 offen offset:1024 nt lds
    s_add_u32 s29, s29, 8192
    v_mfma_f32_16x16x32_bf16 v[132:135], a[100:103], v[64:67], 0
    s_waitcnt lgkmcnt(10)
    v_exp_f32 v104, v104
    v_mfma_f32_16x16x32_bf16 v[136:139], a[104:107], v[64:67], 0
    s_waitcnt lgkmcnt(8)
    ds_read_b128 a[64:67], v4 offset:16384
    v_mfma_f32_16x16x32_bf16 v[140:143], a[108:111], v[64:67], 0
    s_waitcnt lgkmcnt(7)
    v_exp_f32 v105, v105
    v_mfma_f32_16x16x32_bf16 v[144:147], a[112:115], v[64:67], 0
    s_waitcnt lgkmcnt(5)
    ds_read_b128 v[24:27], v2 offset:0
    v_cvt_pk_bf16_f32 v104, v104, v105
    v_mfma_f32_16x16x32_bf16 v[148:151], a[116:119], v[64:67], 0
    s_waitcnt lgkmcnt(4)
    v_exp_f32 v106, v106
    v_mfma_f32_16x16x32_bf16 v[152:155], a[120:123], v[64:67], 0
    s_waitcnt lgkmcnt(2)
    ds_read_b128 a[68:71], v5 offset:16384
    v_mfma_f32_16x16x32_bf16 v[156:159], a[124:127], v[64:67], 0
    v_exp_f32 v107, v107
    v_mfma_f32_16x16x32_bf16 v[32:35], v[44:47], v[72:75], 0
    v_cvt_pk_bf16_f32 v105, v106, v107
    v_mfma_f32_16x16x32_bf16 v[160:163], a[96:99], v[72:75], 0
    v_exp_f32 v108, v108
    v_mfma_f32_16x16x32_bf16 v[164:167], a[100:103], v[72:75], 0
    ds_read_b128 a[72:75], v6 offset:16384
    v_mfma_f32_16x16x32_bf16 v[168:171], a[104:107], v[72:75], 0
    v_exp_f32 v109, v109
    v_mfma_f32_16x16x32_bf16 v[172:175], a[108:111], v[72:75], 0
    v_cvt_pk_bf16_f32 v106, v108, v109
    v_mfma_f32_16x16x32_bf16 v[176:179], a[112:115], v[72:75], 0
    v_exp_f32 v110, v110
    v_mfma_f32_16x16x32_bf16 v[180:183], a[116:119], v[72:75], 0
    ds_read_b128 a[76:79], v7 offset:16384
    v_mfma_f32_16x16x32_bf16 v[184:187], a[120:123], v[72:75], 0
    v_exp_f32 v111, v111
    v_mfma_f32_16x16x32_bf16 v[188:191], a[124:127], v[72:75], 0
    s_add_u32 m0, s44, 49152
    v_cvt_pk_bf16_f32 v107, v110, v111
    v_mfma_f32_16x16x32_bf16 v[36:39], v[44:47], v[80:83], 0
    buffer_load_dwordx4 v16, s[8:11], s28 offen nt lds
    v_mfma_f32_16x16x32_bf16 v[192:195], a[96:99], v[80:83], 0
    v_exp_f32 v112, v112
    v_mfma_f32_16x16x32_bf16 v[196:199], a[100:103], v[80:83], 0
    ds_read_b128 a[80:83], v4 offset:20480
    v_mfma_f32_16x16x32_bf16 v[200:203], a[104:107], v[80:83], 0
    v_exp_f32 v113, v113
    v_mfma_f32_16x16x32_bf16 v[204:207], a[108:111], v[80:83], 0
    v_cvt_pk_bf16_f32 v112, v112, v113
    v_mfma_f32_16x16x32_bf16 v[208:211], a[112:115], v[80:83], 0
    v_exp_f32 v114, v114
    v_mfma_f32_16x16x32_bf16 v[212:215], a[116:119], v[80:83], 0
    ds_read_b128 a[84:87], v5 offset:20480
    v_mfma_f32_16x16x32_bf16 v[216:219], a[120:123], v[80:83], 0
    v_exp_f32 v115, v115
    v_mfma_f32_16x16x32_bf16 v[220:223], a[124:127], v[80:83], 0
    s_waitcnt lgkmcnt(5)
    buffer_store_dwordx4 v[24:27], v20, s[24:27], s43 offen sc0 sc1
    v_cvt_pk_bf16_f32 v113, v114, v115
    v_mfma_f32_16x16x32_bf16 v[40:43], v[44:47], v[88:91], 0
    v_exp_f32 v116, v116
    v_mfma_f32_16x16x32_bf16 v[224:227], a[96:99], v[88:91], 0
    ds_read_b128 a[88:91], v6 offset:20480
    v_mfma_f32_16x16x32_bf16 v[228:231], a[100:103], v[88:91], 0
    v_exp_f32 v117, v117
    v_mfma_f32_16x16x32_bf16 v[232:235], a[104:107], v[88:91], 0
    v_cvt_pk_bf16_f32 v114, v116, v117
    v_mfma_f32_16x16x32_bf16 v[236:239], a[108:111], v[88:91], 0
    v_exp_f32 v118, v118
    v_mfma_f32_16x16x32_bf16 v[240:243], a[112:115], v[88:91], 0
    ds_read_b128 a[92:95], v7 offset:20480
    v_mfma_f32_16x16x32_bf16 v[244:247], a[116:119], v[88:91], 0
    v_exp_f32 v119, v119
    v_mfma_f32_16x16x32_bf16 v[248:251], a[120:123], v[88:91], 0
    v_cvt_pk_bf16_f32 v115, v118, v119
    v_mfma_f32_16x16x32_bf16 v[252:255], a[124:127], v[88:91], 0
    buffer_load_dwordx4 v17, s[8:11], s28 offen offset:1024 nt lds
    s_add_u32 s28, s28, 8192
    s_mov_b32 s33, 0
    s_mov_b32 s30, s44
    .p2align 6
L_LOOP1:
    s_waitcnt lgkmcnt(7)
    v_mfma_f32_16x16x32_bf16 v[64:67], a[64:67], a[0:3], 0
    s_waitcnt vmcnt(12)
    s_barrier
    s_waitcnt lgkmcnt(6)
    v_exp_f32 v120, v120
    v_mfma_f32_16x16x32_bf16 v[64:67], a[68:71], a[4:7], v[64:67]
    s_waitcnt lgkmcnt(5)
    ds_read_b64_tr_b16 a[96:97], v8 offset:8192
    v_mfma_f32_16x16x32_bf16 v[64:67], a[72:75], a[8:11], v[64:67]
    s_waitcnt lgkmcnt(5)
    v_exp_f32 v121, v121
    v_mfma_f32_16x16x32_bf16 v[64:67], a[76:79], a[12:15], v[64:67]
    s_waitcnt lgkmcnt(4)
    ds_read_b64_tr_b16 a[98:99], v8 offset:12288
    v_cvt_pk_bf16_f32 v120, v120, v121
    v_mfma_f32_16x16x32_bf16 v[68:71], a[80:83], a[0:3], 0
    s_waitcnt lgkmcnt(4)
    v_exp_f32 v122, v122
    v_mfma_f32_16x16x32_bf16 v[68:71], a[84:87], a[4:7], v[68:71]
    s_waitcnt lgkmcnt(3)
    ds_read_b64_tr_b16 a[100:101], v9 offset:8192
    v_mfma_f32_16x16x32_bf16 v[68:71], a[88:91], a[8:11], v[68:71]
    s_waitcnt lgkmcnt(3)
    v_exp_f32 v123, v123
    v_mfma_f32_16x16x32_bf16 v[68:71], a[92:95], a[12:15], v[68:71]
    ds_read_b64_tr_b16 a[102:103], v9 offset:12288
    v_cvt_pk_bf16_f32 v121, v122, v123
    v_mfma_f32_16x16x32_bf16 v[72:75], a[64:67], a[16:19], 0
    v_exp_f32 v124, v124
    v_mfma_f32_16x16x32_bf16 v[72:75], a[68:71], a[20:23], v[72:75]
    ds_read_b64_tr_b16 a[104:105], v10 offset:8192
    v_mfma_f32_16x16x32_bf16 v[72:75], a[72:75], a[24:27], v[72:75]
    v_exp_f32 v125, v125
    v_mfma_f32_16x16x32_bf16 v[72:75], a[76:79], a[28:31], v[72:75]
    ds_read_b64_tr_b16 a[106:107], v10 offset:12288
    v_cvt_pk_bf16_f32 v122, v124, v125
    v_mfma_f32_16x16x32_bf16 v[76:79], a[80:83], a[16:19], 0
    v_exp_f32 v126, v126
    v_mfma_f32_16x16x32_bf16 v[76:79], a[84:87], a[20:23], v[76:79]
    ds_read_b64_tr_b16 a[108:109], v11 offset:8192
    v_mfma_f32_16x16x32_bf16 v[76:79], a[88:91], a[24:27], v[76:79]
    v_exp_f32 v127, v127
    v_mfma_f32_16x16x32_bf16 v[76:79], a[92:95], a[28:31], v[76:79]
    s_add_u32 m0, s31, 0
    ds_read_b64_tr_b16 a[110:111], v11 offset:12288
    v_cvt_pk_bf16_f32 v123, v126, v127
    v_mfma_f32_16x16x32_bf16 v[80:83], a[64:67], a[32:35], 0
    buffer_load_dwordx4 v18, s[12:15], s29 offen nt lds
    v_mfma_f32_16x16x32_bf16 v[80:83], a[68:71], a[36:39], v[80:83]
    v_exp_f32 v64, v64
    v_mfma_f32_16x16x32_bf16 v[80:83], a[72:75], a[40:43], v[80:83]
    ds_read_b64_tr_b16 a[112:113], v12 offset:8192
    v_mfma_f32_16x16x32_bf16 v[80:83], a[76:79], a[44:47], v[80:83]
    v_exp_f32 v65, v65
    v_mfma_f32_16x16x32_bf16 v[84:87], a[80:83], a[32:35], 0
    ds_read_b64_tr_b16 a[114:115], v12 offset:12288
    v_cvt_pk_bf16_f32 v64, v64, v65
    v_mfma_f32_16x16x32_bf16 v[84:87], a[84:87], a[36:39], v[84:87]
    v_exp_f32 v66, v66
    v_mfma_f32_16x16x32_bf16 v[84:87], a[88:91], a[40:43], v[84:87]
    ds_read_b64_tr_b16 a[116:117], v13 offset:8192
    v_mfma_f32_16x16x32_bf16 v[84:87], a[92:95], a[44:47], v[84:87]
    v_exp_f32 v67, v67
    v_mfma_f32_16x16x32_bf16 v[88:91], a[64:67], a[48:51], 0
    ds_read_b64_tr_b16 a[118:119], v13 offset:12288
    v_cvt_pk_bf16_f32 v65, v66, v67
    v_mfma_f32_16x16x32_bf16 v[88:91], a[68:71], a[52:55], v[88:91]
    v_exp_f32 v68, v68
    v_mfma_f32_16x16x32_bf16 v[88:91], a[72:75], a[56:59], v[88:91]
    ds_read_b64_tr_b16 a[120:121], v14 offset:8192
    v_mfma_f32_16x16x32_bf16 v[88:91], a[76:79], a[60:63], v[88:91]
    v_exp_f32 v69, v69
    v_mfma_f32_16x16x32_bf16 v[92:95], a[80:83], a[48:51], 0
    ds_read_b64_tr_b16 a[122:123], v14 offset:12288
    v_cvt_pk_bf16_f32 v66, v68, v69
    v_mfma_f32_16x16x32_bf16 v[92:95], a[84:87], a[52:55], v[92:95]
    v_exp_f32 v70, v70
    v_mfma_f32_16x16x32_bf16 v[92:95], a[88:91], a[56:59], v[92:95]
    ds_read_b64_tr_b16 a[124:125], v15 offset:8192
    v_mfma_f32_16x16x32_bf16 v[92:95], a[92:95], a[60:63], v[92:95]
    v_exp_f32 v71, v71
    v_mfma_f32_16x16x32_bf16 v[28:31], v[44:47], v[96:99], v[28:31]
    s_waitcnt lgkmcnt(13)
    ds_read_b64_tr_b16 a[126:127], v15 offset:12288
    v_cvt_pk_bf16_f32 v67, v70, v71
    v_mfma_f32_16x16x32_bf16 v[128:131], a[96:99], v[96:99], v[128:131]
    s_waitcnt lgkmcnt(12)
    buffer_load_dwordx4 v19, s[12:15], s29 offen offset:1024 nt lds
    s_add_u32 s29, s29, 8192
    v_mfma_f32_16x16x32_bf16 v[132:135], a[100:103], v[96:99], v[132:135]
    s_waitcnt lgkmcnt(10)
    v_exp_f32 v72, v72
    v_mfma_f32_16x16x32_bf16 v[136:139], a[104:107], v[96:99], v[136:139]
    s_waitcnt lgkmcnt(8)
    ds_read_b128 a[64:67], v4 offset:24576
    v_mfma_f32_16x16x32_bf16 v[140:143], a[108:111], v[96:99], v[140:143]
    s_waitcnt lgkmcnt(7)
    v_exp_f32 v73, v73
    v_mfma_f32_16x16x32_bf16 v[144:147], a[112:115], v[96:99], v[144:147]
    s_waitcnt lgkmcnt(5)
    ds_read_b128 v[24:27], v2 offset:1024
    v_cvt_pk_bf16_f32 v72, v72, v73
    v_mfma_f32_16x16x32_bf16 v[148:151], a[116:119], v[96:99], v[148:151]
    s_waitcnt lgkmcnt(4)
    v_exp_f32 v74, v74
    v_mfma_f32_16x16x32_bf16 v[152:155], a[120:123], v[96:99], v[152:155]
    s_waitcnt lgkmcnt(2)
    ds_read_b128 a[68:71], v5 offset:24576
    v_mfma_f32_16x16x32_bf16 v[156:159], a[124:127], v[96:99], v[156:159]
    v_exp_f32 v75, v75
    v_mfma_f32_16x16x32_bf16 v[32:35], v[44:47], v[104:107], v[32:35]
    v_cvt_pk_bf16_f32 v73, v74, v75
    v_mfma_f32_16x16x32_bf16 v[160:163], a[96:99], v[104:107], v[160:163]
    v_exp_f32 v76, v76
    v_mfma_f32_16x16x32_bf16 v[164:167], a[100:103], v[104:107], v[164:167]
    ds_read_b128 a[72:75], v6 offset:24576
    v_mfma_f32_16x16x32_bf16 v[168:171], a[104:107], v[104:107], v[168:171]
    v_exp_f32 v77, v77
    v_mfma_f32_16x16x32_bf16 v[172:175], a[108:111], v[104:107], v[172:175]
    v_cvt_pk_bf16_f32 v74, v76, v77
    v_mfma_f32_16x16x32_bf16 v[176:179], a[112:115], v[104:107], v[176:179]
    v_exp_f32 v78, v78
    v_mfma_f32_16x16x32_bf16 v[180:183], a[116:119], v[104:107], v[180:183]
    ds_read_b128 a[76:79], v7 offset:24576
    v_mfma_f32_16x16x32_bf16 v[184:187], a[120:123], v[104:107], v[184:187]
    v_exp_f32 v79, v79
    v_mfma_f32_16x16x32_bf16 v[188:191], a[124:127], v[104:107], v[188:191]
    s_xor_b32 m0, s30, 57344
    v_cvt_pk_bf16_f32 v75, v78, v79
    v_mfma_f32_16x16x32_bf16 v[36:39], v[44:47], v[112:115], v[36:39]
    buffer_load_dwordx4 v16, s[8:11], s28 offen nt lds
    v_mfma_f32_16x16x32_bf16 v[192:195], a[96:99], v[112:115], v[192:195]
    v_exp_f32 v80, v80
    v_mfma_f32_16x16x32_bf16 v[196:199], a[100:103], v[112:115], v[196:199]
    ds_read_b128 a[80:83], v4 offset:28672
    v_mfma_f32_16x16x32_bf16 v[200:203], a[104:107], v[112:115], v[200:203]
    v_exp_f32 v81, v81
    v_mfma_f32_16x16x32_bf16 v[204:207], a[108:111], v[112:115], v[204:207]
    v_cvt_pk_bf16_f32 v80, v80, v81
    v_mfma_f32_16x16x32_bf16 v[208:211], a[112:115], v[112:115], v[208:211]
    v_exp_f32 v82, v82
    v_mfma_f32_16x16x32_bf16 v[212:215], a[116:119], v[112:115], v[212:215]
    ds_read_b128 a[84:87], v5 offset:28672
    v_mfma_f32_16x16x32_bf16 v[216:219], a[120:123], v[112:115], v[216:219]
    v_exp_f32 v83, v83
    v_mfma_f32_16x16x32_bf16 v[220:223], a[124:127], v[112:115], v[220:223]
    s_waitcnt lgkmcnt(5)
    buffer_store_dwordx4 v[24:27], v21, s[24:27], s43 offen sc0 sc1
    v_cvt_pk_bf16_f32 v81, v82, v83
    v_mfma_f32_16x16x32_bf16 v[40:43], v[44:47], v[120:123], v[40:43]
    v_exp_f32 v84, v84
    v_mfma_f32_16x16x32_bf16 v[224:227], a[96:99], v[120:123], v[224:227]
    ds_read_b128 a[88:91], v6 offset:28672
    v_mfma_f32_16x16x32_bf16 v[228:231], a[100:103], v[120:123], v[228:231]
    v_exp_f32 v85, v85
    v_mfma_f32_16x16x32_bf16 v[232:235], a[104:107], v[120:123], v[232:235]
    v_cvt_pk_bf16_f32 v82, v84, v85
    v_mfma_f32_16x16x32_bf16 v[236:239], a[108:111], v[120:123], v[236:239]
    v_exp_f32 v86, v86
    v_mfma_f32_16x16x32_bf16 v[240:243], a[112:115], v[120:123], v[240:243]
    ds_read_b128 a[92:95], v7 offset:28672
    v_mfma_f32_16x16x32_bf16 v[244:247], a[116:119], v[120:123], v[244:247]
    v_exp_f32 v87, v87
    v_mfma_f32_16x16x32_bf16 v[248:251], a[120:123], v[120:123], v[248:251]
    v_cvt_pk_bf16_f32 v83, v86, v87
    v_mfma_f32_16x16x32_bf16 v[252:255], a[124:127], v[120:123], v[252:255]
    buffer_load_dwordx4 v17, s[8:11], s28 offen offset:1024 nt lds
    s_add_u32 s28, s28, 8192
    s_waitcnt lgkmcnt(7)
    v_mfma_f32_16x16x32_bf16 v[96:99], a[64:67], a[0:3], 0
    s_waitcnt vmcnt(12)
    s_barrier
    s_waitcnt lgkmcnt(6)
    v_exp_f32 v88, v88
    v_mfma_f32_16x16x32_bf16 v[96:99], a[68:71], a[4:7], v[96:99]
    s_waitcnt lgkmcnt(5)
    ds_read_b64_tr_b16 a[96:97], v8 offset:16384
    v_xor_b32 v4, 0x8000, v4
    v_mfma_f32_16x16x32_bf16 v[96:99], a[72:75], a[8:11], v[96:99]
    s_waitcnt lgkmcnt(5)
    v_exp_f32 v89, v89
    v_mfma_f32_16x16x32_bf16 v[96:99], a[76:79], a[12:15], v[96:99]
    s_waitcnt lgkmcnt(4)
    ds_read_b64_tr_b16 a[98:99], v8 offset:20480
    v_cvt_pk_bf16_f32 v88, v88, v89
    v_mfma_f32_16x16x32_bf16 v[100:103], a[80:83], a[0:3], 0
    s_waitcnt lgkmcnt(4)
    v_exp_f32 v90, v90
    v_mfma_f32_16x16x32_bf16 v[100:103], a[84:87], a[4:7], v[100:103]
    s_waitcnt lgkmcnt(3)
    ds_read_b64_tr_b16 a[100:101], v9 offset:16384
    v_xor_b32 v5, 0x8000, v5
    v_mfma_f32_16x16x32_bf16 v[100:103], a[88:91], a[8:11], v[100:103]
    s_waitcnt lgkmcnt(3)
    v_exp_f32 v91, v91
    v_mfma_f32_16x16x32_bf16 v[100:103], a[92:95], a[12:15], v[100:103]
    ds_read_b64_tr_b16 a[102:103], v9 offset:20480
    v_cvt_pk_bf16_f32 v89, v90, v91
    v_mfma_f32_16x16x32_bf16 v[104:107], a[64:67], a[16:19], 0
    v_exp_f32 v92, v92
    v_mfma_f32_16x16x32_bf16 v[104:107], a[68:71], a[20:23], v[104:107]
    ds_read_b64_tr_b16 a[104:105], v10 offset:16384
    v_xor_b32 v6, 0x8000, v6
    v_mfma_f32_16x16x32_bf16 v[104:107], a[72:75], a[24:27], v[104:107]
    v_exp_f32 v93, v93
    v_mfma_f32_16x16x32_bf16 v[104:107], a[76:79], a[28:31], v[104:107]
    ds_read_b64_tr_b16 a[106:107], v10 offset:20480
    v_cvt_pk_bf16_f32 v90, v92, v93
    v_mfma_f32_16x16x32_bf16 v[108:111], a[80:83], a[16:19], 0
    v_exp_f32 v94, v94
    v_mfma_f32_16x16x32_bf16 v[108:111], a[84:87], a[20:23], v[108:111]
    ds_read_b64_tr_b16 a[108:109], v11 offset:16384
    v_xor_b32 v7, 0x8000, v7
    v_mfma_f32_16x16x32_bf16 v[108:111], a[88:91], a[24:27], v[108:111]
    v_exp_f32 v95, v95
    v_mfma_f32_16x16x32_bf16 v[108:111], a[92:95], a[28:31], v[108:111]
    s_add_u32 m0, s31, 8192
    ds_read_b64_tr_b16 a[110:111], v11 offset:20480
    v_cvt_pk_bf16_f32 v91, v94, v95
    v_mfma_f32_16x16x32_bf16 v[112:115], a[64:67], a[32:35], 0
    buffer_load_dwordx4 v18, s[12:15], s29 offen nt lds
    v_mfma_f32_16x16x32_bf16 v[112:115], a[68:71], a[36:39], v[112:115]
    v_exp_f32 v96, v96
    v_mfma_f32_16x16x32_bf16 v[112:115], a[72:75], a[40:43], v[112:115]
    ds_read_b64_tr_b16 a[112:113], v12 offset:16384
    v_mfma_f32_16x16x32_bf16 v[112:115], a[76:79], a[44:47], v[112:115]
    v_exp_f32 v97, v97
    v_mfma_f32_16x16x32_bf16 v[116:119], a[80:83], a[32:35], 0
    ds_read_b64_tr_b16 a[114:115], v12 offset:20480
    v_cvt_pk_bf16_f32 v96, v96, v97
    v_mfma_f32_16x16x32_bf16 v[116:119], a[84:87], a[36:39], v[116:119]
    v_exp_f32 v98, v98
    v_mfma_f32_16x16x32_bf16 v[116:119], a[88:91], a[40:43], v[116:119]
    ds_read_b64_tr_b16 a[116:117], v13 offset:16384
    v_mfma_f32_16x16x32_bf16 v[116:119], a[92:95], a[44:47], v[116:119]
    v_exp_f32 v99, v99
    v_mfma_f32_16x16x32_bf16 v[120:123], a[64:67], a[48:51], 0
    ds_read_b64_tr_b16 a[118:119], v13 offset:20480
    v_cvt_pk_bf16_f32 v97, v98, v99
    v_mfma_f32_16x16x32_bf16 v[120:123], a[68:71], a[52:55], v[120:123]
    v_exp_f32 v100, v100
    v_mfma_f32_16x16x32_bf16 v[120:123], a[72:75], a[56:59], v[120:123]
    ds_read_b64_tr_b16 a[120:121], v14 offset:16384
    v_mfma_f32_16x16x32_bf16 v[120:123], a[76:79], a[60:63], v[120:123]
    v_exp_f32 v101, v101
    v_mfma_f32_16x16x32_bf16 v[124:127], a[80:83], a[48:51], 0
    ds_read_b64_tr_b16 a[122:123], v14 offset:20480
    v_cvt_pk_bf16_f32 v98, v100, v101
    v_mfma_f32_16x16x32_bf16 v[124:127], a[84:87], a[52:55], v[124:127]
    v_exp_f32 v102, v102
    v_mfma_f32_16x16x32_bf16 v[124:127], a[88:91], a[56:59], v[124:127]
    ds_read_b64_tr_b16 a[124:125], v15 offset:16384
    v_mfma_f32_16x16x32_bf16 v[124:127], a[92:95], a[60:63], v[124:127]
    v_exp_f32 v103, v103
    v_mfma_f32_16x16x32_bf16 v[28:31], v[44:47], v[64:67], v[28:31]
    s_waitcnt lgkmcnt(13)
    ds_read_b64_tr_b16 a[126:127], v15 offset:20480
    v_cvt_pk_bf16_f32 v99, v102, v103
    v_mfma_f32_16x16x32_bf16 v[128:131], a[96:99], v[64:67], v[128:131]
    s_waitcnt lgkmcnt(12)
    buffer_load_dwordx4 v19, s[12:15], s29 offen offset:1024 nt lds
    s_add_u32 s29, s29, 8192
    v_mfma_f32_16x16x32_bf16 v[132:135], a[100:103], v[64:67], v[132:135]
    s_waitcnt lgkmcnt(10)
    v_exp_f32 v104, v104
    v_mfma_f32_16x16x32_bf16 v[136:139], a[104:107], v[64:67], v[136:139]
    s_waitcnt lgkmcnt(8)
    ds_read_b128 a[64:67], v4 offset:0
    v_mfma_f32_16x16x32_bf16 v[140:143], a[108:111], v[64:67], v[140:143]
    s_waitcnt lgkmcnt(7)
    v_exp_f32 v105, v105
    v_mfma_f32_16x16x32_bf16 v[144:147], a[112:115], v[64:67], v[144:147]
    s_waitcnt lgkmcnt(5)
    ds_read_b128 v[24:27], v2 offset:2048
    v_cvt_pk_bf16_f32 v104, v104, v105
    v_mfma_f32_16x16x32_bf16 v[148:151], a[116:119], v[64:67], v[148:151]
    s_waitcnt lgkmcnt(4)
    v_exp_f32 v106, v106
    v_mfma_f32_16x16x32_bf16 v[152:155], a[120:123], v[64:67], v[152:155]
    s_waitcnt lgkmcnt(2)
    ds_read_b128 a[68:71], v5 offset:0
    v_mfma_f32_16x16x32_bf16 v[156:159], a[124:127], v[64:67], v[156:159]
    v_exp_f32 v107, v107
    v_mfma_f32_16x16x32_bf16 v[32:35], v[44:47], v[72:75], v[32:35]
    v_cvt_pk_bf16_f32 v105, v106, v107
    v_mfma_f32_16x16x32_bf16 v[160:163], a[96:99], v[72:75], v[160:163]
    v_exp_f32 v108, v108
    v_mfma_f32_16x16x32_bf16 v[164:167], a[100:103], v[72:75], v[164:167]
    ds_read_b128 a[72:75], v6 offset:0
    v_mfma_f32_16x16x32_bf16 v[168:171], a[104:107], v[72:75], v[168:171]
    v_exp_f32 v109, v109
    v_mfma_f32_16x16x32_bf16 v[172:175], a[108:111], v[72:75], v[172:175]
    v_cvt_pk_bf16_f32 v106, v108, v109
    v_mfma_f32_16x16x32_bf16 v[176:179], a[112:115], v[72:75], v[176:179]
    v_exp_f32 v110, v110
    v_mfma_f32_16x16x32_bf16 v[180:183], a[116:119], v[72:75], v[180:183]
    ds_read_b128 a[76:79], v7 offset:0
    v_mfma_f32_16x16x32_bf16 v[184:187], a[120:123], v[72:75], v[184:187]
    v_exp_f32 v111, v111
    v_mfma_f32_16x16x32_bf16 v[188:191], a[124:127], v[72:75], v[188:191]
    s_xor_b32 m0, s30, 0
    v_cvt_pk_bf16_f32 v107, v110, v111
    v_mfma_f32_16x16x32_bf16 v[36:39], v[44:47], v[80:83], v[36:39]
    buffer_load_dwordx4 v16, s[8:11], s28 offen nt lds
    v_mfma_f32_16x16x32_bf16 v[192:195], a[96:99], v[80:83], v[192:195]
    v_exp_f32 v112, v112
    v_mfma_f32_16x16x32_bf16 v[196:199], a[100:103], v[80:83], v[196:199]
    ds_read_b128 a[80:83], v4 offset:4096
    v_mfma_f32_16x16x32_bf16 v[200:203], a[104:107], v[80:83], v[200:203]
    v_exp_f32 v113, v113
    v_mfma_f32_16x16x32_bf16 v[204:207], a[108:111], v[80:83], v[204:207]
    v_cvt_pk_bf16_f32 v112, v112, v113
    v_mfma_f32_16x16x32_bf16 v[208:211], a[112:115], v[80:83], v[208:211]
    v_exp_f32 v114, v114
    v_mfma_f32_16x16x32_bf16 v[212:215], a[116:119], v[80:83], v[212:215]
    ds_read_b128 a[84:87], v5 offset:4096
    v_mfma_f32_16x16x32_bf16 v[216:219], a[120:123], v[80:83], v[216:219]
    v_exp_f32 v115, v115
    v_mfma_f32_16x16x32_bf16 v[220:223], a[124:127], v[80:83], v[220:223]
    s_waitcnt lgkmcnt(5)
    buffer_store_dwordx4 v[24:27], v22, s[24:27], s43 offen sc0 sc1
    v_cvt_pk_bf16_f32 v113, v114, v115
    v_mfma_f32_16x16x32_bf16 v[40:43], v[44:47], v[88:91], v[40:43]
    v_exp_f32 v116, v116
    v_mfma_f32_16x16x32_bf16 v[224:227], a[96:99], v[88:91], v[224:227]
    ds_read_b128 a[88:91], v6 offset:4096
    v_mfma_f32_16x16x32_bf16 v[228:231], a[100:103], v[88:91], v[228:231]
    v_exp_f32 v117, v117
    v_mfma_f32_16x16x32_bf16 v[232:235], a[104:107], v[88:91], v[232:235]
    v_cvt_pk_bf16_f32 v114, v116, v117
    v_mfma_f32_16x16x32_bf16 v[236:239], a[108:111], v[88:91], v[236:239]
    v_exp_f32 v118, v118
    v_mfma_f32_16x16x32_bf16 v[240:243], a[112:115], v[88:91], v[240:243]
    ds_read_b128 a[92:95], v7 offset:4096
    v_mfma_f32_16x16x32_bf16 v[244:247], a[116:119], v[88:91], v[244:247]
    v_exp_f32 v119, v119
    v_mfma_f32_16x16x32_bf16 v[248:251], a[120:123], v[88:91], v[248:251]
    v_cvt_pk_bf16_f32 v115, v118, v119
    v_mfma_f32_16x16x32_bf16 v[252:255], a[124:127], v[88:91], v[252:255]
    buffer_load_dwordx4 v17, s[8:11], s28 offen offset:1024 nt lds
    s_add_u32 s28, s28, 8192
    s_cmp_eq_u32 s33, 3
    s_cbranch_scc1 L_DRAIN1
    s_waitcnt lgkmcnt(7)
    v_mfma_f32_16x16x32_bf16 v[64:67], a[64:67], a[0:3], 0
    s_waitcnt vmcnt(13)
    s_barrier
    s_waitcnt lgkmcnt(6)
    v_exp_f32 v120, v120
    v_mfma_f32_16x16x32_bf16 v[64:67], a[68:71], a[4:7], v[64:67]
    s_waitcnt lgkmcnt(5)
    ds_read_b64_tr_b16 a[96:97], v8 offset:24576
    v_mfma_f32_16x16x32_bf16 v[64:67], a[72:75], a[8:11], v[64:67]
    s_waitcnt lgkmcnt(5)
    v_exp_f32 v121, v121
    v_mfma_f32_16x16x32_bf16 v[64:67], a[76:79], a[12:15], v[64:67]
    s_waitcnt lgkmcnt(4)
    ds_read_b64_tr_b16 a[98:99], v8 offset:28672
    v_cvt_pk_bf16_f32 v120, v120, v121
    v_mfma_f32_16x16x32_bf16 v[68:71], a[80:83], a[0:3], 0
    s_waitcnt lgkmcnt(4)
    v_exp_f32 v122, v122
    v_mfma_f32_16x16x32_bf16 v[68:71], a[84:87], a[4:7], v[68:71]
    s_waitcnt lgkmcnt(3)
    ds_read_b64_tr_b16 a[100:101], v9 offset:24576
    v_mfma_f32_16x16x32_bf16 v[68:71], a[88:91], a[8:11], v[68:71]
    s_waitcnt lgkmcnt(3)
    v_exp_f32 v123, v123
    v_mfma_f32_16x16x32_bf16 v[68:71], a[92:95], a[12:15], v[68:71]
    ds_read_b64_tr_b16 a[102:103], v9 offset:28672
    v_cvt_pk_bf16_f32 v121, v122, v123
    v_mfma_f32_16x16x32_bf16 v[72:75], a[64:67], a[16:19], 0
    v_exp_f32 v124, v124
    v_mfma_f32_16x16x32_bf16 v[72:75], a[68:71], a[20:23], v[72:75]
    ds_read_b64_tr_b16 a[104:105], v10 offset:24576
    v_mfma_f32_16x16x32_bf16 v[72:75], a[72:75], a[24:27], v[72:75]
    v_exp_f32 v125, v125
    v_mfma_f32_16x16x32_bf16 v[72:75], a[76:79], a[28:31], v[72:75]
    ds_read_b64_tr_b16 a[106:107], v10 offset:28672
    v_cvt_pk_bf16_f32 v122, v124, v125
    v_mfma_f32_16x16x32_bf16 v[76:79], a[80:83], a[16:19], 0
    v_exp_f32 v126, v126
    v_mfma_f32_16x16x32_bf16 v[76:79], a[84:87], a[20:23], v[76:79]
    ds_read_b64_tr_b16 a[108:109], v11 offset:24576
    v_mfma_f32_16x16x32_bf16 v[76:79], a[88:91], a[24:27], v[76:79]
    v_exp_f32 v127, v127
    v_mfma_f32_16x16x32_bf16 v[76:79], a[92:95], a[28:31], v[76:79]
    s_add_u32 m0, s31, 16384
    ds_read_b64_tr_b16 a[110:111], v11 offset:28672
    v_cvt_pk_bf16_f32 v123, v126, v127
    v_mfma_f32_16x16x32_bf16 v[80:83], a[64:67], a[32:35], 0
    buffer_load_dwordx4 v18, s[12:15], s29 offen nt lds
    v_mfma_f32_16x16x32_bf16 v[80:83], a[68:71], a[36:39], v[80:83]
    v_exp_f32 v64, v64
    v_mfma_f32_16x16x32_bf16 v[80:83], a[72:75], a[40:43], v[80:83]
    ds_read_b64_tr_b16 a[112:113], v12 offset:24576
    v_mfma_f32_16x16x32_bf16 v[80:83], a[76:79], a[44:47], v[80:83]
    v_exp_f32 v65, v65
    v_mfma_f32_16x16x32_bf16 v[84:87], a[80:83], a[32:35], 0
    ds_read_b64_tr_b16 a[114:115], v12 offset:28672
    v_cvt_pk_bf16_f32 v64, v64, v65
    v_mfma_f32_16x16x32_bf16 v[84:87], a[84:87], a[36:39], v[84:87]
    v_exp_f32 v66, v66
    v_mfma_f32_16x16x32_bf16 v[84:87], a[88:91], a[40:43], v[84:87]
    ds_read_b64_tr_b16 a[116:117], v13 offset:24576
    v_mfma_f32_16x16x32_bf16 v[84:87], a[92:95], a[44:47], v[84:87]
    v_exp_f32 v67, v67
    v_mfma_f32_16x16x32_bf16 v[88:91], a[64:67], a[48:51], 0
    ds_read_b64_tr_b16 a[118:119], v13 offset:28672
    v_cvt_pk_bf16_f32 v65, v66, v67
    v_mfma_f32_16x16x32_bf16 v[88:91], a[68:71], a[52:55], v[88:91]
    v_exp_f32 v68, v68
    v_mfma_f32_16x16x32_bf16 v[88:91], a[72:75], a[56:59], v[88:91]
    ds_read_b64_tr_b16 a[120:121], v14 offset:24576
    v_mfma_f32_16x16x32_bf16 v[88:91], a[76:79], a[60:63], v[88:91]
    v_exp_f32 v69, v69
    v_mfma_f32_16x16x32_bf16 v[92:95], a[80:83], a[48:51], 0
    ds_read_b64_tr_b16 a[122:123], v14 offset:28672
    v_cvt_pk_bf16_f32 v66, v68, v69
    v_mfma_f32_16x16x32_bf16 v[92:95], a[84:87], a[52:55], v[92:95]
    v_exp_f32 v70, v70
    v_mfma_f32_16x16x32_bf16 v[92:95], a[88:91], a[56:59], v[92:95]
    ds_read_b64_tr_b16 a[124:125], v15 offset:24576
    v_mfma_f32_16x16x32_bf16 v[92:95], a[92:95], a[60:63], v[92:95]
    v_exp_f32 v71, v71
    v_mfma_f32_16x16x32_bf16 v[28:31], v[44:47], v[96:99], v[28:31]
    s_waitcnt lgkmcnt(13)
    ds_read_b64_tr_b16 a[126:127], v15 offset:28672
    v_cvt_pk_bf16_f32 v67, v70, v71
    v_mfma_f32_16x16x32_bf16 v[128:131], a[96:99], v[96:99], v[128:131]
    s_waitcnt lgkmcnt(12)
    buffer_load_dwordx4 v19, s[12:15], s29 offen offset:1024 nt lds
    s_add_u32 s29, s29, 8192
    v_mfma_f32_16x16x32_bf16 v[132:135], a[100:103], v[96:99], v[132:135]
    s_waitcnt lgkmcnt(10)
    v_exp_f32 v72, v72
    v_mfma_f32_16x16x32_bf16 v[136:139], a[104:107], v[96:99], v[136:139]
    s_waitcnt lgkmcnt(8)
    ds_read_b128 a[64:67], v4 offset:8192
    v_mfma_f32_16x16x32_bf16 v[140:143], a[108:111], v[96:99], v[140:143]
    s_waitcnt lgkmcnt(7)
    v_exp_f32 v73, v73
    v_mfma_f32_16x16x32_bf16 v[144:147], a[112:115], v[96:99], v[144:147]
    s_waitcnt lgkmcnt(5)
    ds_read_b128 v[24:27], v2 offset:3072
    v_cvt_pk_bf16_f32 v72, v72, v73
    v_mfma_f32_16x16x32_bf16 v[148:151], a[116:119], v[96:99], v[148:151]
    s_waitcnt lgkmcnt(4)
    v_exp_f32 v74, v74
    v_mfma_f32_16x16x32_bf16 v[152:155], a[120:123], v[96:99], v[152:155]
    s_waitcnt lgkmcnt(2)
    ds_read_b128 a[68:71], v5 offset:8192
    v_mfma_f32_16x16x32_bf16 v[156:159], a[124:127], v[96:99], v[156:159]
    v_exp_f32 v75, v75
    v_mfma_f32_16x16x32_bf16 v[32:35], v[44:47], v[104:107], v[32:35]
    v_cvt_pk_bf16_f32 v73, v74, v75
    v_mfma_f32_16x16x32_bf16 v[160:163], a[96:99], v[104:107], v[160:163]
    v_exp_f32 v76, v76
    v_mfma_f32_16x16x32_bf16 v[164:167], a[100:103], v[104:107], v[164:167]
    ds_read_b128 a[72:75], v6 offset:8192
    v_mfma_f32_16x16x32_bf16 v[168:171], a[104:107], v[104:107], v[168:171]
    v_exp_f32 v77, v77
    v_mfma_f32_16x16x32_bf16 v[172:175], a[108:111], v[104:107], v[172:175]
    v_cvt_pk_bf16_f32 v74, v76, v77
    v_mfma_f32_16x16x32_bf16 v[176:179], a[112:115], v[104:107], v[176:179]
    v_exp_f32 v78, v78
    v_mfma_f32_16x16x32_bf16 v[180:183], a[116:119], v[104:107], v[180:183]
    ds_read_b128 a[76:79], v7 offset:8192
    v_mfma_f32_16x16x32_bf16 v[184:187], a[120:123], v[104:107], v[184:187]
    v_exp_f32 v79, v79
    v_mfma_f32_16x16x32_bf16 v[188:191], a[124:127], v[104:107], v[188:191]
    s_xor_b32 m0, s30, 8192
    v_cvt_pk_bf16_f32 v75, v78, v79
    v_mfma_f32_16x16x32_bf16 v[36:39], v[44:47], v[112:115], v[36:39]
    buffer_load_dwordx4 v16, s[8:11], s28 offen nt lds
    v_mfma_f32_16x16x32_bf16 v[192:195], a[96:99], v[112:115], v[192:195]
    v_exp_f32 v80, v80
    v_mfma_f32_16x16x32_bf16 v[196:199], a[100:103], v[112:115], v[196:199]
    ds_read_b128 a[80:83], v4 offset:12288
    v_mfma_f32_16x16x32_bf16 v[200:203], a[104:107], v[112:115], v[200:203]
    v_exp_f32 v81, v81
    v_mfma_f32_16x16x32_bf16 v[204:207], a[108:111], v[112:115], v[204:207]
    v_cvt_pk_bf16_f32 v80, v80, v81
    v_mfma_f32_16x16x32_bf16 v[208:211], a[112:115], v[112:115], v[208:211]
    v_exp_f32 v82, v82
    v_mfma_f32_16x16x32_bf16 v[212:215], a[116:119], v[112:115], v[212:215]
    ds_read_b128 a[84:87], v5 offset:12288
    v_mfma_f32_16x16x32_bf16 v[216:219], a[120:123], v[112:115], v[216:219]
    v_exp_f32 v83, v83
    v_mfma_f32_16x16x32_bf16 v[220:223], a[124:127], v[112:115], v[220:223]
    s_waitcnt lgkmcnt(5)
    buffer_store_dwordx4 v[24:27], v23, s[24:27], s43 offen sc0 sc1
    v_cvt_pk_bf16_f32 v81, v82, v83
    v_mfma_f32_16x16x32_bf16 v[40:43], v[44:47], v[120:123], v[40:43]
    v_exp_f32 v84, v84
    v_mfma_f32_16x16x32_bf16 v[224:227], a[96:99], v[120:123], v[224:227]
    ds_read_b128 a[88:91], v6 offset:12288
    v_mfma_f32_16x16x32_bf16 v[228:231], a[100:103], v[120:123], v[228:231]
    v_exp_f32 v85, v85
    v_mfma_f32_16x16x32_bf16 v[232:235], a[104:107], v[120:123], v[232:235]
    v_cvt_pk_bf16_f32 v82, v84, v85
    v_mfma_f32_16x16x32_bf16 v[236:239], a[108:111], v[120:123], v[236:239]
    v_exp_f32 v86, v86
    v_mfma_f32_16x16x32_bf16 v[240:243], a[112:115], v[120:123], v[240:243]
    ds_read_b128 a[92:95], v7 offset:12288
    v_mfma_f32_16x16x32_bf16 v[244:247], a[116:119], v[120:123], v[244:247]
    v_exp_f32 v87, v87
    v_mfma_f32_16x16x32_bf16 v[248:251], a[120:123], v[120:123], v[248:251]
    v_cvt_pk_bf16_f32 v83, v86, v87
    v_mfma_f32_16x16x32_bf16 v[252:255], a[124:127], v[120:123], v[252:255]
    buffer_load_dwordx4 v17, s[8:11], s28 offen offset:1024 nt lds
    s_add_u32 s28, s28, 8192
    s_waitcnt lgkmcnt(7)
    v_mfma_f32_16x16x32_bf16 v[96:99], a[64:67], a[0:3], 0
    s_waitcnt vmcnt(13)
    s_barrier
    s_waitcnt lgkmcnt(6)
    v_exp_f32 v88, v88
    v_mfma_f32_16x16x32_bf16 v[96:99], a[68:71], a[4:7], v[96:99]
    s_waitcnt lgkmcnt(5)
    ds_read_b64_tr_b16 a[96:97], v8 offset:0
    v_mfma_f32_16x16x32_bf16 v[96:99], a[72:75], a[8:11], v[96:99]
    s_waitcnt lgkmcnt(5)
    v_exp_f32 v89, v89
    v_mfma_f32_16x16x32_bf16 v[96:99], a[76:79], a[12:15], v[96:99]
    s_waitcnt lgkmcnt(4)
    ds_read_b64_tr_b16 a[98:99], v8 offset:4096
    v_cvt_pk_bf16_f32 v88, v88, v89
    v_mfma_f32_16x16x32_bf16 v[100:103], a[80:83], a[0:3], 0
    s_waitcnt lgkmcnt(4)
    v_exp_f32 v90, v90
    v_mfma_f32_16x16x32_bf16 v[100:103], a[84:87], a[4:7], v[100:103]
    s_waitcnt lgkmcnt(3)
    ds_read_b64_tr_b16 a[100:101], v9 offset:0
    v_add_u32 v2, 4096, v2
    v_mfma_f32_16x16x32_bf16 v[100:103], a[88:91], a[8:11], v[100:103]
    s_waitcnt lgkmcnt(3)
    v_exp_f32 v91, v91
    v_mfma_f32_16x16x32_bf16 v[100:103], a[92:95], a[12:15], v[100:103]
    ds_read_b64_tr_b16 a[102:103], v9 offset:4096
    v_cvt_pk_bf16_f32 v89, v90, v91
    v_mfma_f32_16x16x32_bf16 v[104:107], a[64:67], a[16:19], 0
    s_add_u32 s43, s43, 4096
    v_exp_f32 v92, v92
    v_mfma_f32_16x16x32_bf16 v[104:107], a[68:71], a[20:23], v[104:107]
    ds_read_b64_tr_b16 a[104:105], v10 offset:0
    v_mfma_f32_16x16x32_bf16 v[104:107], a[72:75], a[24:27], v[104:107]
    v_exp_f32 v93, v93
    v_mfma_f32_16x16x32_bf16 v[104:107], a[76:79], a[28:31], v[104:107]
    ds_read_b64_tr_b16 a[106:107], v10 offset:4096
    v_cvt_pk_bf16_f32 v90, v92, v93
    v_mfma_f32_16x16x32_bf16 v[108:111], a[80:83], a[16:19], 0
    v_exp_f32 v94, v94
    v_mfma_f32_16x16x32_bf16 v[108:111], a[84:87], a[20:23], v[108:111]
    ds_read_b64_tr_b16 a[108:109], v11 offset:0
    v_mfma_f32_16x16x32_bf16 v[108:111], a[88:91], a[24:27], v[108:111]
    v_exp_f32 v95, v95
    v_mfma_f32_16x16x32_bf16 v[108:111], a[92:95], a[28:31], v[108:111]
    s_add_u32 m0, s31, 24576
    ds_read_b64_tr_b16 a[110:111], v11 offset:4096
    v_cvt_pk_bf16_f32 v91, v94, v95
    v_mfma_f32_16x16x32_bf16 v[112:115], a[64:67], a[32:35], 0
    buffer_load_dwordx4 v18, s[12:15], s29 offen nt lds
    v_mfma_f32_16x16x32_bf16 v[112:115], a[68:71], a[36:39], v[112:115]
    v_exp_f32 v96, v96
    v_mfma_f32_16x16x32_bf16 v[112:115], a[72:75], a[40:43], v[112:115]
    ds_read_b64_tr_b16 a[112:113], v12 offset:0
    v_mfma_f32_16x16x32_bf16 v[112:115], a[76:79], a[44:47], v[112:115]
    v_exp_f32 v97, v97
    v_mfma_f32_16x16x32_bf16 v[116:119], a[80:83], a[32:35], 0
    ds_read_b64_tr_b16 a[114:115], v12 offset:4096
    v_cvt_pk_bf16_f32 v96, v96, v97
    v_mfma_f32_16x16x32_bf16 v[116:119], a[84:87], a[36:39], v[116:119]
    v_exp_f32 v98, v98
    v_mfma_f32_16x16x32_bf16 v[116:119], a[88:91], a[40:43], v[116:119]
    ds_read_b64_tr_b16 a[116:117], v13 offset:0
    v_mfma_f32_16x16x32_bf16 v[116:119], a[92:95], a[44:47], v[116:119]
    v_exp_f32 v99, v99
    v_mfma_f32_16x16x32_bf16 v[120:123], a[64:67], a[48:51], 0
    ds_read_b64_tr_b16 a[118:119], v13 offset:4096
    v_cvt_pk_bf16_f32 v97, v98, v99
    v_mfma_f32_16x16x32_bf16 v[120:123], a[68:71], a[52:55], v[120:123]
    v_exp_f32 v100, v100
    v_mfma_f32_16x16x32_bf16 v[120:123], a[72:75], a[56:59], v[120:123]
    ds_read_b64_tr_b16 a[120:121], v14 offset:0
    v_mfma_f32_16x16x32_bf16 v[120:123], a[76:79], a[60:63], v[120:123]
    v_exp_f32 v101, v101
    v_mfma_f32_16x16x32_bf16 v[124:127], a[80:83], a[48:51], 0
    ds_read_b64_tr_b16 a[122:123], v14 offset:4096
    v_cvt_pk_bf16_f32 v98, v100, v101
    v_mfma_f32_16x16x32_bf16 v[124:127], a[84:87], a[52:55], v[124:127]
    v_exp_f32 v102, v102
    v_mfma_f32_16x16x32_bf16 v[124:127], a[88:91], a[56:59], v[124:127]
    ds_read_b64_tr_b16 a[124:125], v15 offset:0
    v_mfma_f32_16x16x32_bf16 v[124:127], a[92:95], a[60:63], v[124:127]
    v_exp_f32 v103, v103
    v_mfma_f32_16x16x32_bf16 v[28:31], v[44:47], v[64:67], v[28:31]
    s_waitcnt lgkmcnt(13)
    ds_read_b64_tr_b16 a[126:127], v15 offset:4096
    v_cvt_pk_bf16_f32 v99, v102, v103
    v_mfma_f32_16x16x32_bf16 v[128:131], a[96:99], v[64:67], v[128:131]
    s_waitcnt lgkmcnt(12)
    buffer_load_dwordx4 v19, s[12:15], s29 offen offset:1024 nt lds
    s_add_u32 s29, s29, 8192
    v_mfma_f32_16x16x32_bf16 v[132:135], a[100:103], v[64:67], v[132:135]
    s_waitcnt lgkmcnt(10)
    v_exp_f32 v104, v104
    v_mfma_f32_16x16x32_bf16 v[136:139], a[104:107], v[64:67], v[136:139]
    s_waitcnt lgkmcnt(8)
    ds_read_b128 a[64:67], v4 offset:16384
    v_mfma_f32_16x16x32_bf16 v[140:143], a[108:111], v[64:67], v[140:143]
    s_waitcnt lgkmcnt(7)
    v_exp_f32 v105, v105
    v_mfma_f32_16x16x32_bf16 v[144:147], a[112:115], v[64:67], v[144:147]
    s_waitcnt lgkmcnt(5)
    ds_read_b128 v[24:27], v2 offset:0
    v_cvt_pk_bf16_f32 v104, v104, v105
    v_mfma_f32_16x16x32_bf16 v[148:151], a[116:119], v[64:67], v[148:151]
    s_waitcnt lgkmcnt(4)
    v_exp_f32 v106, v106
    v_mfma_f32_16x16x32_bf16 v[152:155], a[120:123], v[64:67], v[152:155]
    s_waitcnt lgkmcnt(2)
    ds_read_b128 a[68:71], v5 offset:16384
    v_mfma_f32_16x16x32_bf16 v[156:159], a[124:127], v[64:67], v[156:159]
    v_exp_f32 v107, v107
    v_mfma_f32_16x16x32_bf16 v[32:35], v[44:47], v[72:75], v[32:35]
    v_cvt_pk_bf16_f32 v105, v106, v107
    v_mfma_f32_16x16x32_bf16 v[160:163], a[96:99], v[72:75], v[160:163]
    v_exp_f32 v108, v108
    v_mfma_f32_16x16x32_bf16 v[164:167], a[100:103], v[72:75], v[164:167]
    ds_read_b128 a[72:75], v6 offset:16384
    v_mfma_f32_16x16x32_bf16 v[168:171], a[104:107], v[72:75], v[168:171]
    v_exp_f32 v109, v109
    v_mfma_f32_16x16x32_bf16 v[172:175], a[108:111], v[72:75], v[172:175]
    v_cvt_pk_bf16_f32 v106, v108, v109
    v_mfma_f32_16x16x32_bf16 v[176:179], a[112:115], v[72:75], v[176:179]
    v_exp_f32 v110, v110
    v_mfma_f32_16x16x32_bf16 v[180:183], a[116:119], v[72:75], v[180:183]
    ds_read_b128 a[76:79], v7 offset:16384
    v_mfma_f32_16x16x32_bf16 v[184:187], a[120:123], v[72:75], v[184:187]
    v_exp_f32 v111, v111
    v_mfma_f32_16x16x32_bf16 v[188:191], a[124:127], v[72:75], v[188:191]
    s_xor_b32 m0, s30, 16384
    v_cvt_pk_bf16_f32 v107, v110, v111
    v_mfma_f32_16x16x32_bf16 v[36:39], v[44:47], v[80:83], v[36:39]
    buffer_load_dwordx4 v16, s[8:11], s28 offen nt lds
    v_mfma_f32_16x16x32_bf16 v[192:195], a[96:99], v[80:83], v[192:195]
    v_exp_f32 v112, v112
    v_mfma_f32_16x16x32_bf16 v[196:199], a[100:103], v[80:83], v[196:199]
    ds_read_b128 a[80:83], v4 offset:20480
    v_mfma_f32_16x16x32_bf16 v[200:203], a[104:107], v[80:83], v[200:203]
    v_exp_f32 v113, v113
    v_mfma_f32_16x16x32_bf16 v[204:207], a[108:111], v[80:83], v[204:207]
    v_cvt_pk_bf16_f32 v112, v112, v113
    v_mfma_f32_16x16x32_bf16 v[208:211], a[112:115], v[80:83], v[208:211]
    v_exp_f32 v114, v114
    v_mfma_f32_16x16x32_bf16 v[212:215], a[116:119], v[80:83], v[212:215]
    ds_read_b128 a[84:87], v5 offset:20480
    v_mfma_f32_16x16x32_bf16 v[216:219], a[120:123], v[80:83], v[216:219]
    v_exp_f32 v115, v115
    v_mfma_f32_16x16x32_bf16 v[220:223], a[124:127], v[80:83], v[220:223]
    s_waitcnt lgkmcnt(5)
    buffer_store_dwordx4 v[24:27], v20, s[24:27], s43 offen sc0 sc1
    v_cvt_pk_bf16_f32 v113, v114, v115
    v_mfma_f32_16x16x32_bf16 v[40:43], v[44:47], v[88:91], v[40:43]
    v_exp_f32 v116, v116
    v_mfma_f32_16x16x32_bf16 v[224:227], a[96:99], v[88:91], v[224:227]
    ds_read_b128 a[88:91], v6 offset:20480
    v_mfma_f32_16x16x32_bf16 v[228:231], a[100:103], v[88:91], v[228:231]
    v_exp_f32 v117, v117
    v_mfma_f32_16x16x32_bf16 v[232:235], a[104:107], v[88:91], v[232:235]
    v_cvt_pk_bf16_f32 v114, v116, v117
    v_mfma_f32_16x16x32_bf16 v[236:239], a[108:111], v[88:91], v[236:239]
    v_exp_f32 v118, v118
    v_mfma_f32_16x16x32_bf16 v[240:243], a[112:115], v[88:91], v[240:243]
    ds_read_b128 a[92:95], v7 offset:20480
    v_mfma_f32_16x16x32_bf16 v[244:247], a[116:119], v[88:91], v[244:247]
    v_exp_f32 v119, v119
    v_mfma_f32_16x16x32_bf16 v[248:251], a[120:123], v[88:91], v[248:251]
    v_cvt_pk_bf16_f32 v115, v118, v119
    v_mfma_f32_16x16x32_bf16 v[252:255], a[124:127], v[88:91], v[252:255]
    buffer_load_dwordx4 v17, s[8:11], s28 offen offset:1024 nt lds
    s_add_u32 s28, s28, 8192
    s_add_u32 s33, s33, 1
    s_xor_b32 s30, s30, 0x8000
    s_branch L_LOOP1
L_DRAIN1:
    s_waitcnt vmcnt(13)
    s_barrier
    v_mfma_f32_16x16x32_bf16 v[28:31], v[44:47], v[96:99], v[28:31]
    ds_read_b64_tr_b16 a[96:97], v8 offset:24576
    ds_read_b64_tr_b16 a[98:99], v8 offset:28672
    ds_read_b64_tr_b16 a[100:101], v9 offset:24576
    ds_read_b64_tr_b16 a[102:103], v9 offset:28672
    ds_read_b64_tr_b16 a[104:105], v10 offset:24576
    ds_read_b64_tr_b16 a[106:107], v10 offset:28672
    ds_read_b64_tr_b16 a[108:109], v11 offset:24576
    ds_read_b64_tr_b16 a[110:111], v11 offset:28672
    ds_read_b64_tr_b16 a[112:113], v12 offset:24576
    ds_read_b64_tr_b16 a[114:115], v12 offset:28672
    ds_read_b64_tr_b16 a[116:117], v13 offset:24576
    ds_read_b64_tr_b16 a[118:119], v13 offset:28672
    ds_read_b64_tr_b16 a[120:121], v14 offset:24576
    ds_read_b64_tr_b16 a[122:123], v14 offset:28672
    ds_read_b64_tr_b16 a[124:125], v15 offset:24576
    ds_read_b64_tr_b16 a[126:127], v15 offset:28672
    ds_read_b128 v[24:27], v2 offset:3072
    v_exp_f32 v120, v120
    v_exp_f32 v121, v121
    v_exp_f32 v122, v122
    v_cvt_pk_bf16_f32 v120, v120, v121
    v_exp_f32 v123, v123
    v_exp_f32 v124, v124
    v_cvt_pk_bf16_f32 v121, v122, v123
    v_exp_f32 v125, v125
    v_exp_f32 v126, v126
    v_cvt_pk_bf16_f32 v122, v124, v125
    v_exp_f32 v127, v127
    s_nop 0
    v_cvt_pk_bf16_f32 v123, v126, v127
    s_waitcnt lgkmcnt(15)
    v_mfma_f32_16x16x32_bf16 v[128:131], a[96:99], v[96:99], v[128:131]
    s_waitcnt lgkmcnt(0)
    buffer_store_dwordx4 v[24:27], v23, s[24:27], s43 offen sc0 sc1
    v_mfma_f32_16x16x32_bf16 v[132:135], a[100:103], v[96:99], v[132:135]
    v_and_b32 v57, 15, v0
    v_bfe_u32 v56, v0, 5, 1
    v_bfe_u32 v58, v0, 4, 1
    v_mfma_f32_16x16x32_bf16 v[136:139], a[104:107], v[96:99], v[136:139]
    v_xor_b32 v56, v56, v57
    v_lshlrev_b32 v56, 4, v56
    v_lshl_add_u32 v56, v58, 3, v56
    v_mfma_f32_16x16x32_bf16 v[140:143], a[108:111], v[96:99], v[140:143]
    v_lshl_add_u32 v56, v57, 8, v56
    v_add_u32 v56, s45, v56
    v_xor_b32 v63, 224, v56
    v_mfma_f32_16x16x32_bf16 v[144:147], a[112:115], v[96:99], v[144:147]
    v_xor_b32 v62, 192, v56
    v_xor_b32 v61, 160, v56
    v_xor_b32 v60, 128, v56
    v_mfma_f32_16x16x32_bf16 v[148:151], a[116:119], v[96:99], v[148:151]
    v_xor_b32 v59, 96, v56
    v_xor_b32 v58, 64, v56
    v_xor_b32 v57, 32, v56
    v_mfma_f32_16x16x32_bf16 v[152:155], a[120:123], v[96:99], v[152:155]
    v_subrev_u32 v2, 12288, v2
    v_mfma_f32_16x16x32_bf16 v[156:159], a[124:127], v[96:99], v[156:159]
    v_mfma_f32_16x16x32_bf16 v[32:35], v[44:47], v[104:107], v[32:35]
    v_mfma_f32_16x16x32_bf16 v[160:163], a[96:99], v[104:107], v[160:163]
    v_mfma_f32_16x16x32_bf16 v[164:167], a[100:103], v[104:107], v[164:167]
    v_rcp_f32 v30, v28
    s_nop 0
    v_pk_mul_f32 v[128:129], v[128:129], v[30:31] op_sel_hi:[1,0]
    v_pk_mul_f32 v[130:131], v[130:131], v[30:31] op_sel_hi:[1,0]
    v_pk_mul_f32 v[132:133], v[132:133], v[30:31] op_sel_hi:[1,0]
    v_pk_mul_f32 v[134:135], v[134:135], v[30:31] op_sel_hi:[1,0]
    v_mfma_f32_16x16x32_bf16 v[168:171], a[104:107], v[104:107], v[168:171]
    v_cvt_pk_bf16_f32 v128, v128, v129
    v_cvt_pk_bf16_f32 v129, v130, v131
    v_cvt_pk_bf16_f32 v132, v132, v133
    v_cvt_pk_bf16_f32 v133, v134, v135
    v_pk_mul_f32 v[136:137], v[136:137], v[30:31] op_sel_hi:[1,0]
    v_pk_mul_f32 v[138:139], v[138:139], v[30:31] op_sel_hi:[1,0]
    v_pk_mul_f32 v[140:141], v[140:141], v[30:31] op_sel_hi:[1,0]
    v_pk_mul_f32 v[142:143], v[142:143], v[30:31] op_sel_hi:[1,0]
    v_mfma_f32_16x16x32_bf16 v[172:175], a[108:111], v[104:107], v[172:175]
    ds_write_b64 v56, v[128:129] offset:0
    ds_write_b64 v57, v[132:133] offset:0
    v_mfma_f32_16x16x32_bf16 v[176:179], a[112:115], v[104:107], v[176:179]
    v_cvt_pk_bf16_f32 v136, v136, v137
    v_cvt_pk_bf16_f32 v137, v138, v139
    v_cvt_pk_bf16_f32 v140, v140, v141
    v_cvt_pk_bf16_f32 v141, v142, v143
    v_pk_mul_f32 v[144:145], v[144:145], v[30:31] op_sel_hi:[1,0]
    v_pk_mul_f32 v[146:147], v[146:147], v[30:31] op_sel_hi:[1,0]
    v_pk_mul_f32 v[148:149], v[148:149], v[30:31] op_sel_hi:[1,0]
    v_pk_mul_f32 v[150:151], v[150:151], v[30:31] op_sel_hi:[1,0]
    v_mfma_f32_16x16x32_bf16 v[180:183], a[116:119], v[104:107], v[180:183]
    ds_write_b64 v58, v[136:137] offset:0
    ds_write_b64 v59, v[140:141] offset:0
    v_mfma_f32_16x16x32_bf16 v[184:187], a[120:123], v[104:107], v[184:187]
    v_cvt_pk_bf16_f32 v144, v144, v145
    v_cvt_pk_bf16_f32 v145, v146, v147
    v_cvt_pk_bf16_f32 v148, v148, v149
    v_cvt_pk_bf16_f32 v149, v150, v151
    v_pk_mul_f32 v[152:153], v[152:153], v[30:31] op_sel_hi:[1,0]
    v_pk_mul_f32 v[154:155], v[154:155], v[30:31] op_sel_hi:[1,0]
    v_pk_mul_f32 v[156:157], v[156:157], v[30:31] op_sel_hi:[1,0]
    v_pk_mul_f32 v[158:159], v[158:159], v[30:31] op_sel_hi:[1,0]
    v_mfma_f32_16x16x32_bf16 v[188:191], a[124:127], v[104:107], v[188:191]
    ds_write_b64 v60, v[144:145] offset:0
    ds_write_b64 v61, v[148:149] offset:0
    v_mfma_f32_16x16x32_bf16 v[36:39], v[44:47], v[112:115], v[36:39]
    v_cvt_pk_bf16_f32 v152, v152, v153
    v_cvt_pk_bf16_f32 v153, v154, v155
    v_cvt_pk_bf16_f32 v156, v156, v157
    v_cvt_pk_bf16_f32 v157, v158, v159
    v_mfma_f32_16x16x32_bf16 v[192:195], a[96:99], v[112:115], v[192:195]
    ds_write_b64 v62, v[152:153] offset:0
    ds_write_b64 v63, v[156:157] offset:0
    v_mfma_f32_16x16x32_bf16 v[196:199], a[100:103], v[112:115], v[196:199]
    ds_read_b128 v[136:139], v2 offset:0
    ds_read_b128 v[140:143], v2 offset:1024
    ds_read_b128 v[144:147], v2 offset:2048
    v_mfma_f32_16x16x32_bf16 v[200:203], a[104:107], v[112:115], v[200:203]
    ds_read_b128 v[148:151], v2 offset:3072
    v_rcp_f32 v34, v32
    s_nop 0
    v_pk_mul_f32 v[160:161], v[160:161], v[34:35] op_sel_hi:[1,0]
    v_pk_mul_f32 v[162:163], v[162:163], v[34:35] op_sel_hi:[1,0]
    v_pk_mul_f32 v[164:165], v[164:165], v[34:35] op_sel_hi:[1,0]
    v_pk_mul_f32 v[166:167], v[166:167], v[34:35] op_sel_hi:[1,0]
    v_mfma_f32_16x16x32_bf16 v[204:207], a[108:111], v[112:115], v[204:207]
    v_cvt_pk_bf16_f32 v160, v160, v161
    v_cvt_pk_bf16_f32 v161, v162, v163
    v_cvt_pk_bf16_f32 v164, v164, v165
    v_cvt_pk_bf16_f32 v165, v166, v167
    v_pk_mul_f32 v[168:169], v[168:169], v[34:35] op_sel_hi:[1,0]
    v_pk_mul_f32 v[170:171], v[170:171], v[34:35] op_sel_hi:[1,0]
    v_pk_mul_f32 v[172:173], v[172:173], v[34:35] op_sel_hi:[1,0]
    v_pk_mul_f32 v[174:175], v[174:175], v[34:35] op_sel_hi:[1,0]
    v_mfma_f32_16x16x32_bf16 v[208:211], a[112:115], v[112:115], v[208:211]
    ds_write_b64 v56, v[160:161] offset:4096
    ds_write_b64 v57, v[164:165] offset:4096
    v_mfma_f32_16x16x32_bf16 v[212:215], a[116:119], v[112:115], v[212:215]
    v_cvt_pk_bf16_f32 v168, v168, v169
    v_cvt_pk_bf16_f32 v169, v170, v171
    v_cvt_pk_bf16_f32 v172, v172, v173
    v_cvt_pk_bf16_f32 v173, v174, v175
    v_pk_mul_f32 v[176:177], v[176:177], v[34:35] op_sel_hi:[1,0]
    v_pk_mul_f32 v[178:179], v[178:179], v[34:35] op_sel_hi:[1,0]
    v_pk_mul_f32 v[180:181], v[180:181], v[34:35] op_sel_hi:[1,0]
    v_pk_mul_f32 v[182:183], v[182:183], v[34:35] op_sel_hi:[1,0]
    v_mfma_f32_16x16x32_bf16 v[216:219], a[120:123], v[112:115], v[216:219]
    ds_write_b64 v58, v[168:169] offset:4096
    ds_write_b64 v59, v[172:173] offset:4096
    v_mfma_f32_16x16x32_bf16 v[220:223], a[124:127], v[112:115], v[220:223]
    v_cvt_pk_bf16_f32 v176, v176, v177
    v_cvt_pk_bf16_f32 v177, v178, v179
    v_cvt_pk_bf16_f32 v180, v180, v181
    v_cvt_pk_bf16_f32 v181, v182, v183
    v_pk_mul_f32 v[184:185], v[184:185], v[34:35] op_sel_hi:[1,0]
    v_pk_mul_f32 v[186:187], v[186:187], v[34:35] op_sel_hi:[1,0]
    v_pk_mul_f32 v[188:189], v[188:189], v[34:35] op_sel_hi:[1,0]
    v_pk_mul_f32 v[190:191], v[190:191], v[34:35] op_sel_hi:[1,0]
    v_mfma_f32_16x16x32_bf16 v[40:43], v[44:47], v[120:123], v[40:43]
    ds_write_b64 v60, v[176:177] offset:4096
    ds_write_b64 v61, v[180:181] offset:4096
    v_mfma_f32_16x16x32_bf16 v[224:227], a[96:99], v[120:123], v[224:227]
    v_cvt_pk_bf16_f32 v184, v184, v185
    v_cvt_pk_bf16_f32 v185, v186, v187
    v_cvt_pk_bf16_f32 v188, v188, v189
    v_cvt_pk_bf16_f32 v189, v190, v191
    v_mfma_f32_16x16x32_bf16 v[228:231], a[100:103], v[120:123], v[228:231]
    ds_write_b64 v62, v[184:185] offset:4096
    ds_write_b64 v63, v[188:189] offset:4096
    v_mfma_f32_16x16x32_bf16 v[232:235], a[104:107], v[120:123], v[232:235]
    ds_read_b128 v[168:171], v2 offset:4096
    ds_read_b128 v[172:175], v2 offset:5120
    ds_read_b128 v[176:179], v2 offset:6144
    v_mfma_f32_16x16x32_bf16 v[236:239], a[108:111], v[120:123], v[236:239]
    ds_read_b128 v[180:183], v2 offset:7168
    s_waitcnt lgkmcnt(15)
    buffer_store_dwordx4 v[136:139], v20, s[20:23], s64 offen sc0 sc1
    v_mfma_f32_16x16x32_bf16 v[240:243], a[112:115], v[120:123], v[240:243]
    s_waitcnt lgkmcnt(14)
    buffer_store_dwordx4 v[140:143], v21, s[20:23], s64 offen sc0 sc1
    v_mfma_f32_16x16x32_bf16 v[244:247], a[116:119], v[120:123], v[244:247]
    s_waitcnt lgkmcnt(13)
    buffer_store_dwordx4 v[144:147], v22, s[20:23], s64 offen sc0 sc1
    v_mfma_f32_16x16x32_bf16 v[248:251], a[120:123], v[120:123], v[248:251]
    s_waitcnt lgkmcnt(12)
    buffer_store_dwordx4 v[148:151], v23, s[20:23], s64 offen sc0 sc1
    v_mfma_f32_16x16x32_bf16 v[252:255], a[124:127], v[120:123], v[252:255]
    v_rcp_f32 v38, v36
    s_nop 0
    v_pk_mul_f32 v[192:193], v[192:193], v[38:39] op_sel_hi:[1,0]
    v_pk_mul_f32 v[194:195], v[194:195], v[38:39] op_sel_hi:[1,0]
    v_pk_mul_f32 v[196:197], v[196:197], v[38:39] op_sel_hi:[1,0]
    v_pk_mul_f32 v[198:199], v[198:199], v[38:39] op_sel_hi:[1,0]
    v_cvt_pk_bf16_f32 v192, v192, v193
    v_cvt_pk_bf16_f32 v193, v194, v195
    v_cvt_pk_bf16_f32 v196, v196, v197
    v_cvt_pk_bf16_f32 v197, v198, v199
    v_pk_mul_f32 v[200:201], v[200:201], v[38:39] op_sel_hi:[1,0]
    v_pk_mul_f32 v[202:203], v[202:203], v[38:39] op_sel_hi:[1,0]
    v_pk_mul_f32 v[204:205], v[204:205], v[38:39] op_sel_hi:[1,0]
    v_pk_mul_f32 v[206:207], v[206:207], v[38:39] op_sel_hi:[1,0]
    ds_write_b64 v56, v[192:193] offset:8192
    ds_write_b64 v57, v[196:197] offset:8192
    v_cvt_pk_bf16_f32 v200, v200, v201
    v_cvt_pk_bf16_f32 v201, v202, v203
    v_cvt_pk_bf16_f32 v204, v204, v205
    v_cvt_pk_bf16_f32 v205, v206, v207
    v_pk_mul_f32 v[208:209], v[208:209], v[38:39] op_sel_hi:[1,0]
    v_pk_mul_f32 v[210:211], v[210:211], v[38:39] op_sel_hi:[1,0]
    v_pk_mul_f32 v[212:213], v[212:213], v[38:39] op_sel_hi:[1,0]
    v_pk_mul_f32 v[214:215], v[214:215], v[38:39] op_sel_hi:[1,0]
    ds_write_b64 v58, v[200:201] offset:8192
    ds_write_b64 v59, v[204:205] offset:8192
    v_cvt_pk_bf16_f32 v208, v208, v209
    v_cvt_pk_bf16_f32 v209, v210, v211
    v_cvt_pk_bf16_f32 v212, v212, v213
    v_cvt_pk_bf16_f32 v213, v214, v215
    v_pk_mul_f32 v[216:217], v[216:217], v[38:39] op_sel_hi:[1,0]
    v_pk_mul_f32 v[218:219], v[218:219], v[38:39] op_sel_hi:[1,0]
    v_pk_mul_f32 v[220:221], v[220:221], v[38:39] op_sel_hi:[1,0]
    v_pk_mul_f32 v[222:223], v[222:223], v[38:39] op_sel_hi:[1,0]
    ds_write_b64 v60, v[208:209] offset:8192
    ds_write_b64 v61, v[212:213] offset:8192
    v_cvt_pk_bf16_f32 v216, v216, v217
    v_cvt_pk_bf16_f32 v217, v218, v219
    v_cvt_pk_bf16_f32 v220, v220, v221
    v_cvt_pk_bf16_f32 v221, v222, v223
    ds_write_b64 v62, v[216:217] offset:8192
    ds_write_b64 v63, v[220:221] offset:8192
    ds_read_b128 v[200:203], v2 offset:8192
    ds_read_b128 v[204:207], v2 offset:9216
    ds_read_b128 v[208:211], v2 offset:10240
    ds_read_b128 v[212:215], v2 offset:11264
    s_waitcnt lgkmcnt(15)
    buffer_store_dwordx4 v[168:171], v20, s[20:23], s65 offen sc0 sc1
    s_waitcnt lgkmcnt(14)
    buffer_store_dwordx4 v[172:175], v21, s[20:23], s65 offen sc0 sc1
    s_waitcnt lgkmcnt(13)
    buffer_store_dwordx4 v[176:179], v22, s[20:23], s65 offen sc0 sc1
    s_waitcnt lgkmcnt(12)
    buffer_store_dwordx4 v[180:183], v23, s[20:23], s65 offen sc0 sc1
    v_rcp_f32 v42, v40
    s_nop 0
    v_pk_mul_f32 v[224:225], v[224:225], v[42:43] op_sel_hi:[1,0]
    v_pk_mul_f32 v[226:227], v[226:227], v[42:43] op_sel_hi:[1,0]
    v_pk_mul_f32 v[228:229], v[228:229], v[42:43] op_sel_hi:[1,0]
    v_pk_mul_f32 v[230:231], v[230:231], v[42:43] op_sel_hi:[1,0]
    v_cvt_pk_bf16_f32 v224, v224, v225
    v_cvt_pk_bf16_f32 v225, v226, v227
    v_cvt_pk_bf16_f32 v228, v228, v229
    v_cvt_pk_bf16_f32 v229, v230, v231
    v_pk_mul_f32 v[232:233], v[232:233], v[42:43] op_sel_hi:[1,0]
    v_pk_mul_f32 v[234:235], v[234:235], v[42:43] op_sel_hi:[1,0]
    v_pk_mul_f32 v[236:237], v[236:237], v[42:43] op_sel_hi:[1,0]
    v_pk_mul_f32 v[238:239], v[238:239], v[42:43] op_sel_hi:[1,0]
    ds_write_b64 v56, v[224:225] offset:12288
    ds_write_b64 v57, v[228:229] offset:12288
    v_cvt_pk_bf16_f32 v232, v232, v233
    v_cvt_pk_bf16_f32 v233, v234, v235
    v_cvt_pk_bf16_f32 v236, v236, v237
    v_cvt_pk_bf16_f32 v237, v238, v239
    v_pk_mul_f32 v[240:241], v[240:241], v[42:43] op_sel_hi:[1,0]
    v_pk_mul_f32 v[242:243], v[242:243], v[42:43] op_sel_hi:[1,0]
    v_pk_mul_f32 v[244:245], v[244:245], v[42:43] op_sel_hi:[1,0]
    v_pk_mul_f32 v[246:247], v[246:247], v[42:43] op_sel_hi:[1,0]
    ds_write_b64 v58, v[232:233] offset:12288
    ds_write_b64 v59, v[236:237] offset:12288
    v_cvt_pk_bf16_f32 v240, v240, v241
    v_cvt_pk_bf16_f32 v241, v242, v243
    v_cvt_pk_bf16_f32 v244, v244, v245
    v_cvt_pk_bf16_f32 v245, v246, v247
    v_pk_mul_f32 v[248:249], v[248:249], v[42:43] op_sel_hi:[1,0]
    v_pk_mul_f32 v[250:251], v[250:251], v[42:43] op_sel_hi:[1,0]
    v_pk_mul_f32 v[252:253], v[252:253], v[42:43] op_sel_hi:[1,0]
    v_pk_mul_f32 v[254:255], v[254:255], v[42:43] op_sel_hi:[1,0]
    ds_write_b64 v60, v[240:241] offset:12288
    ds_write_b64 v61, v[244:245] offset:12288
    v_cvt_pk_bf16_f32 v248, v248, v249
    v_cvt_pk_bf16_f32 v249, v250, v251
    v_cvt_pk_bf16_f32 v252, v252, v253
    v_cvt_pk_bf16_f32 v253, v254, v255
    ds_write_b64 v62, v[248:249] offset:12288
    ds_write_b64 v63, v[252:253] offset:12288
    ds_read_b128 v[232:235], v2 offset:12288
    ds_read_b128 v[236:239], v2 offset:13312
    ds_read_b128 v[240:243], v2 offset:14336
    ds_read_b128 v[244:247], v2 offset:15360
    s_waitcnt lgkmcnt(15)
    buffer_store_dwordx4 v[200:203], v20, s[20:23], s66 offen sc0 sc1
    s_waitcnt lgkmcnt(14)
    buffer_store_dwordx4 v[204:207], v21, s[20:23], s66 offen sc0 sc1
    s_waitcnt lgkmcnt(13)
    buffer_store_dwordx4 v[208:211], v22, s[20:23], s66 offen sc0 sc1
    s_waitcnt lgkmcnt(12)
    buffer_store_dwordx4 v[212:215], v23, s[20:23], s66 offen sc0 sc1
    s_waitcnt lgkmcnt(3)
    buffer_store_dwordx4 v[232:235], v20, s[20:23], s67 offen sc0 sc1
    s_waitcnt lgkmcnt(2)
    buffer_store_dwordx4 v[236:239], v21, s[20:23], s67 offen sc0 sc1
    s_waitcnt lgkmcnt(1)
    buffer_store_dwordx4 v[240:243], v22, s[20:23], s67 offen sc0 sc1
    s_waitcnt lgkmcnt(0)
    buffer_store_dwordx4 v[244:247], v23, s[20:23], s67 offen sc0 sc1
    v_min3_f32 v64, v28, v32, v36
    v_add_f32 v65, v28, v32
    v_add_f32 v66, v36, v40
    v_min_f32 v64, v64, v40
    v_add_f32 v65, v65, v66
    v_cmp_le_f32 vcc, 0x30800000, v64
    s_mov_b64 s[46:47], vcc
    v_cmp_ge_f32 vcc, 0x54800000, v65
    s_and_b64 s[46:47], s[46:47], vcc
    s_cmp_eq_u64 s[46:47], -1
    s_cselect_b32 s46, 0, 2
    s_or_b32 s37, s37, s46
    s_cmp_lg_u32 s37, 0
    s_cbranch_scc1 L_SLOW
L_FAST_END:
    s_branch L_END
L_SLOW:
    s_waitcnt vmcnt(0) lgkmcnt(0)
    s_mov_b32 s70, 0
L_SLOW_UNIT:
    s_lshr_b32 s72, s37, s70
    s_and_b32 s72, s72, 1
    s_cmp_eq_u32 s72, 0
    s_cbranch_scc1 L_SLOW_NEXT
    s_cmp_eq_u32 s70, 0
    s_cselect_b32 s72, s40, s38
    s_cselect_b32 s73, s41, s39
    s_add_u32 s16, s56, s72
    s_addc_u32 s17, s57, 0
    s_and_b32 s17, s17, 0xffff
    s_mov_b32 s18, s73
    s_mov_b32 s19, 0x20000
    s_add_u32 s20, s62, s72
    s_addc_u32 s21, s63, 0
    s_and_b32 s21, s21, 0xffff
    s_mov_b32 s22, s73
    s_mov_b32 s23, 0x20000
    s_lshl_b32 s71, s70, 17
    s_add_u32 s71, s71, s10
    s_sub_u32 s71, s71, 0x40000
    s_add_u32 m0, s45, 0
    s_nop 0
    buffer_load_dwordx4 v20, s[16:19], s64 offen lds
    s_add_u32 m0, s45, 1024
    s_nop 0
    buffer_load_dwordx4 v21, s[16:19], s64 offen lds
    s_add_u32 m0, s45, 2048
    s_nop 0
    buffer_load_dwordx4 v22, s[16:19], s64 offen lds
    s_add_u32 m0, s45, 3072
    s_nop 0
    buffer_load_dwordx4 v23, s[16:19], s64 offen lds
    s_add_u32 m0, s45, 4096
    s_nop 0
    buffer_load_dwordx4 v20, s[16:19], s65 offen lds
    s_add_u32 m0, s45, 5120
    s_nop 0
    buffer_load_dwordx4 v21, s[16:19], s65 offen lds
    s_add_u32 m0, s45, 6144
    s_nop 0
    buffer_load_dwordx4 v22, s[16:19], s65 offen lds
    s_add_u32 m0, s45, 7168
    s_nop 0
    buffer_load_dwordx4 v23, s[16:19], s65 offen lds
    s_add_u32 m0, s45, 8192
    s_nop 0
    buffer_load_dwordx4 v20, s[16:19], s66 offen lds
    s_add_u32 m0, s45, 9216
    s_nop 0
    buffer_load_dwordx4 v21, s[16:19], s66 offen lds
    s_add_u32 m0, s45, 10240
    s_nop 0
    buffer_load_dwordx4 v22, s[16:19], s66 offen lds
    s_add_u32 m0, s45, 11264
    s_nop 0
    buffer_load_dwordx4 v23, s[16:19], s66 offen lds
    s_add_u32 m0, s45, 12288
    s_nop 0
    buffer_load_dwordx4 v20, s[16:19], s67 offen lds
    s_add_u32 m0, s45, 13312
    s_nop 0
    buffer_load_dwordx4 v21, s[16:19], s67 offen lds
    s_add_u32 m0, s45, 14336
    s_nop 0
    buffer_load_dwordx4 v22, s[16:19], s67 offen lds
    s_add_u32 m0, s45, 15360
    s_nop 0
    buffer_load_dwordx4 v23, s[16:19], s67 offen lds
    v_add_u32 v56, s45, v4
    v_add_u32 v57, s45, v5
    v_add_u32 v58, s45, v6
    v_add_u32 v59, s45, v7
    s_waitcnt vmcnt(0)
    ds_read_b128 v[96:99], v56 offset:0
    ds_read_b128 v[104:107], v57 offset:0
    ds_read_b128 v[112:115], v58 offset:0
    ds_read_b128 v[120:123], v59 offset:0
    s_waitcnt lgkmcnt(3)
    v_lshlrev_b32 v48, 16, v96
    v_and_b32 v49, 0xffff0000, v96
    v_lshlrev_b32 v50, 16, v97
    v_and_b32 v51, 0xffff0000, v97
    v_lshlrev_b32 v52, 16, v98
    v_and_b32 v53, 0xffff0000, v98
    v_lshlrev_b32 v54, 16, v99
    v_and_b32 v55, 0xffff0000, v99
    v_pk_mul_f32 v[48:49], v[48:49], s[34:35]
    v_pk_mul_f32 v[50:51], v[50:51], s[34:35]
    v_pk_mul_f32 v[52:53], v[52:53], s[34:35]
    v_pk_mul_f32 v[54:55], v[54:55], s[34:35]
    v_cvt_pk_bf16_f32 v96, v48, v49
    v_cvt_pk_bf16_f32 v97, v50, v51
    v_cvt_pk_bf16_f32 v98, v52, v53
    v_cvt_pk_bf16_f32 v99, v54, v55
    v_accvgpr_write_b32 a0, v96
    v_accvgpr_write_b32 a1, v97
    v_accvgpr_write_b32 a2, v98
    v_accvgpr_write_b32 a3, v99
    s_waitcnt lgkmcnt(2)
    v_lshlrev_b32 v48, 16, v104
    v_and_b32 v49, 0xffff0000, v104
    v_lshlrev_b32 v50, 16, v105
    v_and_b32 v51, 0xffff0000, v105
    v_lshlrev_b32 v52, 16, v106
    v_and_b32 v53, 0xffff0000, v106
    v_lshlrev_b32 v54, 16, v107
    v_and_b32 v55, 0xffff0000, v107
    v_pk_mul_f32 v[48:49], v[48:49], s[34:35]
    v_pk_mul_f32 v[50:51], v[50:51], s[34:35]
    v_pk_mul_f32 v[52:53], v[52:53], s[34:35]
    v_pk_mul_f32 v[54:55], v[54:55], s[34:35]
    v_cvt_pk_bf16_f32 v104, v48, v49
    v_cvt_pk_bf16_f32 v105, v50, v51
    v_cvt_pk_bf16_f32 v106, v52, v53
    v_cvt_pk_bf16_f32 v107, v54, v55
    v_accvgpr_write_b32 a4, v104
    v_accvgpr_write_b32 a5, v105
    v_accvgpr_write_b32 a6, v106
    v_accvgpr_write_b32 a7, v107
    s_waitcnt lgkmcnt(1)
    v_lshlrev_b32 v48, 16, v112
    v_and_b32 v49, 0xffff0000, v112
    v_lshlrev_b32 v50, 16, v113
    v_and_b32 v51, 0xffff0000, v113
    v_lshlrev_b32 v52, 16, v114
    v_and_b32 v53, 0xffff0000, v114
    v_lshlrev_b32 v54, 16, v115
    v_and_b32 v55, 0xffff0000, v115
    v_pk_mul_f32 v[48:49], v[48:49], s[34:35]
    v_pk_mul_f32 v[50:51], v[50:51], s[34:35]
    v_pk_mul_f32 v[52:53], v[52:53], s[34:35]
    v_pk_mul_f32 v[54:55], v[54:55], s[34:35]
    v_cvt_pk_bf16_f32 v112, v48, v49
    v_cvt_pk_bf16_f32 v113, v50, v51
    v_cvt_pk_bf16_f32 v114, v52, v53
    v_cvt_pk_bf16_f32 v115, v54, v55
    v_accvgpr_write_b32 a8, v112
    v_accvgpr_write_b32 a9, v113
    v_accvgpr_write_b32 a10, v114
    v_accvgpr_write_b32 a11, v115
    s_waitcnt lgkmcnt(0)
    v_lshlrev_b32 v48, 16, v120
    v_and_b32 v49, 0xffff0000, v120
    v_lshlrev_b32 v50, 16, v121
    v_and_b32 v51, 0xffff0000, v121
    v_lshlrev_b32 v52, 16, v122
    v_and_b32 v53, 0xffff0000, v122
    v_lshlrev_b32 v54, 16, v123
    v_and_b32 v55, 0xffff0000, v123
    v_pk_mul_f32 v[48:49], v[48:49], s[34:35]
    v_pk_mul_f32 v[50:51], v[50:51], s[34:35]
    v_pk_mul_f32 v[52:53], v[52:53], s[34:35]
    v_pk_mul_f32 v[54:55], v[54:55], s[34:35]
    v_cvt_pk_bf16_f32 v120, v48, v49
    v_cvt_pk_bf16_f32 v121, v50, v51
    v_cvt_pk_bf16_f32 v122, v52, v53
    v_cvt_pk_bf16_f32 v123, v54, v55
    v_accvgpr_write_b32 a12, v120
    v_accvgpr_write_b32 a13, v121
    v_accvgpr_write_b32 a14, v122
    v_accvgpr_write_b32 a15, v123
    ds_read_b128 v[96:99], v56 offset:4096
    ds_read_b128 v[104:107], v57 offset:4096
    ds_read_b128 v[112:115], v58 offset:4096
    ds_read_b128 v[120:123], v59 offset:4096
    s_waitcnt lgkmcnt(3)
    v_lshlrev_b32 v48, 16, v96
    v_and_b32 v49, 0xffff0000, v96
    v_lshlrev_b32 v50, 16, v97
    v_and_b32 v51, 0xffff0000, v97
    v_lshlrev_b32 v52, 16, v98
    v_and_b32 v53, 0xffff0000, v98
    v_lshlrev_b32 v54, 16, v99
    v_and_b32 v55, 0xffff0000, v99
    v_pk_mul_f32 v[48:49], v[48:49], s[34:35]
    v_pk_mul_f32 v[50:51], v[50:51], s[34:35]
    v_pk_mul_f32 v[52:53], v[52:53], s[34:35]
    v_pk_mul_f32 v[54:55], v[54:55], s[34:35]
    v_cvt_pk_bf16_f32 v96, v48, v49
    v_cvt_pk_bf16_f32 v97, v50, v51
    v_cvt_pk_bf16_f32 v98, v52, v53
    v_cvt_pk_bf16_f32 v99, v54, v55
    v_accvgpr_write_b32 a16, v96
    v_accvgpr_write_b32 a17, v97
    v_accvgpr_write_b32 a18, v98
    v_accvgpr_write_b32 a19, v99
    s_waitcnt lgkmcnt(2)
    v_lshlrev_b32 v48, 16, v104
    v_and_b32 v49, 0xffff0000, v104
    v_lshlrev_b32 v50, 16, v105
    v_and_b32 v51, 0xffff0000, v105
    v_lshlrev_b32 v52, 16, v106
    v_and_b32 v53, 0xffff0000, v106
    v_lshlrev_b32 v54, 16, v107
    v_and_b32 v55, 0xffff0000, v107
    v_pk_mul_f32 v[48:49], v[48:49], s[34:35]
    v_pk_mul_f32 v[50:51], v[50:51], s[34:35]
    v_pk_mul_f32 v[52:53], v[52:53], s[34:35]
    v_pk_mul_f32 v[54:55], v[54:55], s[34:35]
    v_cvt_pk_bf16_f32 v104, v48, v49
    v_cvt_pk_bf16_f32 v105, v50, v51
    v_cvt_pk_bf16_f32 v106, v52, v53
    v_cvt_pk_bf16_f32 v107, v54, v55
    v_accvgpr_write_b32 a20, v104
    v_accvgpr_write_b32 a21, v105
    v_accvgpr_write_b32 a22, v106
    v_accvgpr_write_b32 a23, v107
    s_waitcnt lgkmcnt(1)
    v_lshlrev_b32 v48, 16, v112
    v_and_b32 v49, 0xffff0000, v112
    v_lshlrev_b32 v50, 16, v113
    v_and_b32 v51, 0xffff0000, v113
    v_lshlrev_b32 v52, 16, v114
    v_and_b32 v53, 0xffff0000, v114
    v_lshlrev_b32 v54, 16, v115
    v_and_b32 v55, 0xffff0000, v115
    v_pk_mul_f32 v[48:49], v[48:49], s[34:35]
    v_pk_mul_f32 v[50:51], v[50:51], s[34:35]
    v_pk_mul_f32 v[52:53], v[52:53], s[34:35]
    v_pk_mul_f32 v[54:55], v[54:55], s[34:35]
    v_cvt_pk_bf16_f32 v112, v48, v49
    v_cvt_pk_bf16_f32 v113, v50, v51
    v_cvt_pk_bf16_f32 v114, v52, v53
    v_cvt_pk_bf16_f32 v115, v54, v55
    v_accvgpr_write_b32 a24, v112
    v_accvgpr_write_b32 a25, v113
    v_accvgpr_write_b32 a26, v114
    v_accvgpr_write_b32 a27, v115
    s_waitcnt lgkmcnt(0)
    v_lshlrev_b32 v48, 16, v120
    v_and_b32 v49, 0xffff0000, v120
    v_lshlrev_b32 v50, 16, v121
    v_and_b32 v51, 0xffff0000, v121
    v_lshlrev_b32 v52, 16, v122
    v_and_b32 v53, 0xffff0000, v122
    v_lshlrev_b32 v54, 16, v123
    v_and_b32 v55, 0xffff0000, v123
    v_pk_mul_f32 v[48:49], v[48:49], s[34:35]
    v_pk_mul_f32 v[50:51], v[50:51], s[34:35]
    v_pk_mul_f32 v[52:53], v[52:53], s[34:35]
    v_pk_mul_f32 v[54:55], v[54:55], s[34:35]
    v_cvt_pk_bf16_f32 v120, v48, v49
    v_cvt_pk_bf16_f32 v121, v50, v51
    v_cvt_pk_bf16_f32 v122, v52, v53
    v_cvt_pk_bf16_f32 v123, v54, v55
    v_accvgpr_write_b32 a28, v120
    v_accvgpr_write_b32 a29, v121
    v_accvgpr_write_b32 a30, v122
    v_accvgpr_write_b32 a31, v123
    ds_read_b128 v[96:99], v56 offset:8192
    ds_read_b128 v[104:107], v57 offset:8192
    ds_read_b128 v[112:115], v58 offset:8192
    ds_read_b128 v[120:123], v59 offset:8192
    s_waitcnt lgkmcnt(3)
    v_lshlrev_b32 v48, 16, v96
    v_and_b32 v49, 0xffff0000, v96
    v_lshlrev_b32 v50, 16, v97
    v_and_b32 v51, 0xffff0000, v97
    v_lshlrev_b32 v52, 16, v98
    v_and_b32 v53, 0xffff0000, v98
    v_lshlrev_b32 v54, 16, v99
    v_and_b32 v55, 0xffff0000, v99
    v_pk_mul_f32 v[48:49], v[48:49], s[34:35]
    v_pk_mul_f32 v[50:51], v[50:51], s[34:35]
    v_pk_mul_f32 v[52:53], v[52:53], s[34:35]
    v_pk_mul_f32 v[54:55], v[54:55], s[34:35]
    v_cvt_pk_bf16_f32 v96, v48, v49
    v_cvt_pk_bf16_f32 v97, v50, v51
    v_cvt_pk_bf16_f32 v98, v52, v53
    v_cvt_pk_bf16_f32 v99, v54, v55
    v_accvgpr_write_b32 a32, v96
    v_accvgpr_write_b32 a33, v97
    v_accvgpr_write_b32 a34, v98
    v_accvgpr_write_b32 a35, v99
    s_waitcnt lgkmcnt(2)
    v_lshlrev_b32 v48, 16, v104
    v_and_b32 v49, 0xffff0000, v104
    v_lshlrev_b32 v50, 16, v105
    v_and_b32 v51, 0xffff0000, v105
    v_lshlrev_b32 v52, 16, v106
    v_and_b32 v53, 0xffff0000, v106
    v_lshlrev_b32 v54, 16, v107
    v_and_b32 v55, 0xffff0000, v107
    v_pk_mul_f32 v[48:49], v[48:49], s[34:35]
    v_pk_mul_f32 v[50:51], v[50:51], s[34:35]
    v_pk_mul_f32 v[52:53], v[52:53], s[34:35]
    v_pk_mul_f32 v[54:55], v[54:55], s[34:35]
    v_cvt_pk_bf16_f32 v104, v48, v49
    v_cvt_pk_bf16_f32 v105, v50, v51
    v_cvt_pk_bf16_f32 v106, v52, v53
    v_cvt_pk_bf16_f32 v107, v54, v55
    v_accvgpr_write_b32 a36, v104
    v_accvgpr_write_b32 a37, v105
    v_accvgpr_write_b32 a38, v106
    v_accvgpr_write_b32 a39, v107
    s_waitcnt lgkmcnt(1)
    v_lshlrev_b32 v48, 16, v112
    v_and_b32 v49, 0xffff0000, v112
    v_lshlrev_b32 v50, 16, v113
    v_and_b32 v51, 0xffff0000, v113
    v_lshlrev_b32 v52, 16, v114
    v_and_b32 v53, 0xffff0000, v114
    v_lshlrev_b32 v54, 16, v115
    v_and_b32 v55, 0xffff0000, v115
    v_pk_mul_f32 v[48:49], v[48:49], s[34:35]
    v_pk_mul_f32 v[50:51], v[50:51], s[34:35]
    v_pk_mul_f32 v[52:53], v[52:53], s[34:35]
    v_pk_mul_f32 v[54:55], v[54:55], s[34:35]
    v_cvt_pk_bf16_f32 v112, v48, v49
    v_cvt_pk_bf16_f32 v113, v50, v51
    v_cvt_pk_bf16_f32 v114, v52, v53
    v_cvt_pk_bf16_f32 v115, v54, v55
    v_accvgpr_write_b32 a40, v112
    v_accvgpr_write_b32 a41, v113
    v_accvgpr_write_b32 a42, v114
    v_accvgpr_write_b32 a43, v115
    s_waitcnt lgkmcnt(0)
    v_lshlrev_b32 v48, 16, v120
    v_and_b32 v49, 0xffff0000, v120
    v_lshlrev_b32 v50, 16, v121
    v_and_b32 v51, 0xffff0000, v121
    v_lshlrev_b32 v52, 16, v122
    v_and_b32 v53, 0xffff0000, v122
    v_lshlrev_b32 v54, 16, v123
    v_and_b32 v55, 0xffff0000, v123
    v_pk_mul_f32 v[48:49], v[48:49], s[34:35]
    v_pk_mul_f32 v[50:51], v[50:51], s[34:35]
    v_pk_mul_f32 v[52:53], v[52:53], s[34:35]
    v_pk_mul_f32 v[54:55], v[54:55], s[34:35]
    v_cvt_pk_bf16_f32 v120, v48, v49
    v_cvt_pk_bf16_f32 v121, v50, v51
    v_cvt_pk_bf16_f32 v122, v52, v53
    v_cvt_pk_bf16_f32 v123, v54, v55
    v_accvgpr_write_b32 a44, v120
    v_accvgpr_write_b32 a45, v121
    v_accvgpr_write_b32 a46, v122
    v_accvgpr_write_b32 a47, v123
    ds_read_b128 v[96:99], v56 offset:12288
    ds_read_b128 v[104:107], v57 offset:12288
    ds_read_b128 v[112:115], v58 offset:12288
    ds_read_b128 v[120:123], v59 offset:12288
    s_waitcnt lgkmcnt(3)
    v_lshlrev_b32 v48, 16, v96
    v_and_b32 v49, 0xffff0000, v96
    v_lshlrev_b32 v50, 16, v97
    v_and_b32 v51, 0xffff0000, v97
    v_lshlrev_b32 v52, 16, v98
    v_and_b32 v53, 0xffff0000, v98
    v_lshlrev_b32 v54, 16, v99
    v_and_b32 v55, 0xffff0000, v99
    v_pk_mul_f32 v[48:49], v[48:49], s[34:35]
    v_pk_mul_f32 v[50:51], v[50:51], s[34:35]
    v_pk_mul_f32 v[52:53], v[52:53], s[34:35]
    v_pk_mul_f32 v[54:55], v[54:55], s[34:35]
    v_cvt_pk_bf16_f32 v96, v48, v49
    v_cvt_pk_bf16_f32 v97, v50, v51
    v_cvt_pk_bf16_f32 v98, v52, v53
    v_cvt_pk_bf16_f32 v99, v54, v55
    v_accvgpr_write_b32 a48, v96
    v_accvgpr_write_b32 a49, v97
    v_accvgpr_write_b32 a50, v98
    v_accvgpr_write_b32 a51, v99
    s_waitcnt lgkmcnt(2)
    v_lshlrev_b32 v48, 16, v104
    v_and_b32 v49, 0xffff0000, v104
    v_lshlrev_b32 v50, 16, v105
    v_and_b32 v51, 0xffff0000, v105
    v_lshlrev_b32 v52, 16, v106
    v_and_b32 v53, 0xffff0000, v106
    v_lshlrev_b32 v54, 16, v107
    v_and_b32 v55, 0xffff0000, v107
    v_pk_mul_f32 v[48:49], v[48:49], s[34:35]
    v_pk_mul_f32 v[50:51], v[50:51], s[34:35]
    v_pk_mul_f32 v[52:53], v[52:53], s[34:35]
    v_pk_mul_f32 v[54:55], v[54:55], s[34:35]
    v_cvt_pk_bf16_f32 v104, v48, v49
    v_cvt_pk_bf16_f32 v105, v50, v51
    v_cvt_pk_bf16_f32 v106, v52, v53
    v_cvt_pk_bf16_f32 v107, v54, v55
    v_accvgpr_write_b32 a52, v104
    v_accvgpr_write_b32 a53, v105
    v_accvgpr_write_b32 a54, v106
    v_accvgpr_write_b32 a55, v107
    s_waitcnt lgkmcnt(1)
    v_lshlrev_b32 v48, 16, v112
    v_and_b32 v49, 0xffff0000, v112
    v_lshlrev_b32 v50, 16, v113
    v_and_b32 v51, 0xffff0000, v113
    v_lshlrev_b32 v52, 16, v114
    v_and_b32 v53, 0xffff0000, v114
    v_lshlrev_b32 v54, 16, v115
    v_and_b32 v55, 0xffff0000, v115
    v_pk_mul_f32 v[48:49], v[48:49], s[34:35]
    v_pk_mul_f32 v[50:51], v[50:51], s[34:35]
    v_pk_mul_f32 v[52:53], v[52:53], s[34:35]
    v_pk_mul_f32 v[54:55], v[54:55], s[34:35]
    v_cvt_pk_bf16_f32 v112, v48, v49
    v_cvt_pk_bf16_f32 v113, v50, v51
    v_cvt_pk_bf16_f32 v114, v52, v53
    v_cvt_pk_bf16_f32 v115, v54, v55
    v_accvgpr_write_b32 a56, v112
    v_accvgpr_write_b32 a57, v113
    v_accvgpr_write_b32 a58, v114
    v_accvgpr_write_b32 a59, v115
    s_waitcnt lgkmcnt(0)
    v_lshlrev_b32 v48, 16, v120
    v_and_b32 v49, 0xffff0000, v120
    v_lshlrev_b32 v50, 16, v121
    v_and_b32 v51, 0xffff0000, v121
    v_lshlrev_b32 v52, 16, v122
    v_and_b32 v53, 0xffff0000, v122
    v_lshlrev_b32 v54, 16, v123
    v_and_b32 v55, 0xffff0000, v123
    v_pk_mul_f32 v[48:49], v[48:49], s[34:35]
    v_pk_mul_f32 v[50:51], v[50:51], s[34:35]
    v_pk_mul_f32 v[52:53], v[52:53], s[34:35]
    v_pk_mul_f32 v[54:55], v[54:55], s[34:35]
    v_cvt_pk_bf16_f32 v120, v48, v49
    v_cvt_pk_bf16_f32 v121, v50, v51
    v_cvt_pk_bf16_f32 v122, v52, v53
    v_cvt_pk_bf16_f32 v123, v54, v55
    v_accvgpr_write_b32 a60, v120
    v_accvgpr_write_b32 a61, v121
    v_accvgpr_write_b32 a62, v122
    v_accvgpr_write_b32 a63, v123
    s_lshl_b32 s72, s32, 14
    v_subrev_u32 v108, s72, v20
    v_subrev_u32 v109, s72, v21
    v_subrev_u32 v110, s72, v22
    v_subrev_u32 v111, s72, v23
    s_lshl_b32 s72, s32, 11
    v_subrev_u32 v112, s72, v18
    v_subrev_u32 v113, s72, v19
    v_add_u32 v113, 1024, v113
    s_add_u32 s72, s45, 8192
    s_sub_u32 s72, s72, 65536
    v_add_u32 v96, s72, v8
    v_add_u32 v97, s72, v9
    v_add_u32 v98, s72, v10
    v_add_u32 v99, s72, v11
    v_add_u32 v100, s72, v12
    v_add_u32 v101, s72, v13
    v_add_u32 v102, s72, v14
    v_add_u32 v103, s72, v15
    v_mov_b32 v104, 0xff800000
    v_mov_b32 v105, 0xff800000
    v_mov_b32 v106, 0xff800000
    v_mov_b32 v107, 0xff800000
    s_mov_b32 s73, s71
    s_add_u32 s74, s71, 0x20000
L_SLOW_P1:
    s_add_u32 m0, s45, 0
    s_add_u32 s72, s73, 0
    buffer_load_dwordx4 v108, s[8:11], s72 offen lds
    s_add_u32 m0, s45, 1024
    s_add_u32 s72, s73, 0
    buffer_load_dwordx4 v109, s[8:11], s72 offen lds
    s_add_u32 m0, s45, 2048
    s_add_u32 s72, s73, 0
    buffer_load_dwordx4 v110, s[8:11], s72 offen lds
    s_add_u32 m0, s45, 3072
    s_add_u32 s72, s73, 0
    buffer_load_dwordx4 v111, s[8:11], s72 offen lds
    s_add_u32 m0, s45, 4096
    s_add_u32 s72, s73, 4096
    buffer_load_dwordx4 v108, s[8:11], s72 offen lds
    s_add_u32 m0, s45, 5120
    s_add_u32 s72, s73, 4096
    buffer_load_dwordx4 v109, s[8:11], s72 offen lds
    s_add_u32 m0, s45, 6144
    s_add_u32 s72, s73, 4096
    buffer_load_dwordx4 v110, s[8:11], s72 offen lds
    s_add_u32 m0, s45, 7168
    s_add_u32 s72, s73, 4096
    buffer_load_dwordx4 v111, s[8:11], s72 offen lds
    s_waitcnt vmcnt(0)
    ds_read_b128 a[64:67], v56 offset:0
    ds_read_b128 a[68:71], v57 offset:0
    ds_read_b128 a[72:75], v58 offset:0
    ds_read_b128 a[76:79], v59 offset:0
    ds_read_b128 a[80:83], v56 offset:4096
    ds_read_b128 a[84:87], v57 offset:4096
    ds_read_b128 a[88:91], v58 offset:4096
    ds_read_b128 a[92:95], v59 offset:4096
    s_waitcnt lgkmcnt(0)
    v_mfma_f32_16x16x32_bf16 v[64:67], a[64:67], a[0:3], 0
    v_mfma_f32_16x16x32_bf16 v[64:67], a[68:71], a[4:7], v[64:67]
    v_mfma_f32_16x16x32_bf16 v[64:67], a[72:75], a[8:11], v[64:67]
    v_mfma_f32_16x16x32_bf16 v[64:67], a[76:79], a[12:15], v[64:67]
    v_mfma_f32_16x16x32_bf16 v[68:71], a[80:83], a[0:3], 0
    v_mfma_f32_16x16x32_bf16 v[68:71], a[84:87], a[4:7], v[68:71]
    v_mfma_f32_16x16x32_bf16 v[68:71], a[88:91], a[8:11], v[68:71]
    v_mfma_f32_16x16x32_bf16 v[68:71], a[92:95], a[12:15], v[68:71]
    v_mfma_f32_16x16x32_bf16 v[72:75], a[64:67], a[16:19], 0
    v_mfma_f32_16x16x32_bf16 v[72:75], a[68:71], a[20:23], v[72:75]
    v_mfma_f32_16x16x32_bf16 v[72:75], a[72:75], a[24:27], v[72:75]
    v_mfma_f32_16x16x32_bf16 v[72:75], a[76:79], a[28:31], v[72:75]
    v_mfma_f32_16x16x32_bf16 v[76:79], a[80:83], a[16:19], 0
    v_mfma_f32_16x16x32_bf16 v[76:79], a[84:87], a[20:23], v[76:79]
    v_mfma_f32_16x16x32_bf16 v[76:79], a[88:91], a[24:27], v[76:79]
    v_mfma_f32_16x16x32_bf16 v[76:79], a[92:95], a[28:31], v[76:79]
    v_mfma_f32_16x16x32_bf16 v[80:83], a[64:67], a[32:35], 0
    v_mfma_f32_16x16x32_bf16 v[80:83], a[68:71], a[36:39], v[80:83]
    v_mfma_f32_16x16x32_bf16 v[80:83], a[72:75], a[40:43], v[80:83]
    v_mfma_f32_16x16x32_bf16 v[80:83], a[76:79], a[44:47], v[80:83]
    v_mfma_f32_16x16x32_bf16 v[84:87], a[80:83], a[32:35], 0
    v_mfma_f32_16x16x32_bf16 v[84:87], a[84:87], a[36:39], v[84:87]
    v_mfma_f32_16x16x32_bf16 v[84:87], a[88:91], a[40:43], v[84:87]
    v_mfma_f32_16x16x32_bf16 v[84:87], a[92:95], a[44:47], v[84:87]
    v_mfma_f32_16x16x32_bf16 v[88:91], a[64:67], a[48:51], 0
    v_mfma_f32_16x16x32_bf16 v[88:91], a[68:71], a[52:55], v[88:91]
    v_mfma_f32_16x16x32_bf16 v[88:91], a[72:75], a[56:59], v[88:91]
    v_mfma_f32_16x16x32_bf16 v[88:91], a[76:79], a[60:63], v[88:91]
    v_mfma_f32_16x16x32_bf16 v[92:95], a[80:83], a[48:51], 0
    v_mfma_f32_16x16x32_bf16 v[92:95], a[84:87], a[52:55], v[92:95]
    v_mfma_f32_16x16x32_bf16 v[92:95], a[88:91], a[56:59], v[92:95]
    v_mfma_f32_16x16x32_bf16 v[92:95], a[92:95], a[60:63], v[92:95]
    s_nop 7
    v_max3_f32 v104, v104, v64, v65
    v_max3_f32 v104, v104, v66, v67
    v_max3_f32 v104, v104, v68, v69
    v_max3_f32 v104, v104, v70, v71
    v_max3_f32 v105, v105, v72, v73
    v_max3_f32 v105, v105, v74, v75
    v_max3_f32 v105, v105, v76, v77
    v_max3_f32 v105, v105, v78, v79
    v_max3_f32 v106, v106, v80, v81
    v_max3_f32 v106, v106, v82, v83
    v_max3_f32 v106, v106, v84, v85
    v_max3_f32 v106, v106, v86, v87
    v_max3_f32 v107, v107, v88, v89
    v_max3_f32 v107, v107, v90, v91
    v_max3_f32 v107, v107, v92, v93
    v_max3_f32 v107, v107, v94, v95
    s_add_u32 s73, s73, 8192
    s_cmp_lt_u32 s73, s74
    s_cbranch_scc1 L_SLOW_P1
    v_mov_b32 v114, v104
    v_mov_b32 v115, v105
    v_mov_b32 v116, v106
    v_mov_b32 v117, v107
    s_nop 1
    v_permlane32_swap_b32 v104, v114
    v_permlane32_swap_b32 v105, v115
    v_permlane32_swap_b32 v106, v116
    v_permlane32_swap_b32 v107, v117
    v_max_f32 v104, v104, v114
    v_max_f32 v105, v105, v115
    v_max_f32 v106, v106, v116
    v_max_f32 v107, v107, v117
    v_mov_b32 v114, v104
    v_mov_b32 v115, v105
    v_mov_b32 v116, v106
    v_mov_b32 v117, v107
    s_nop 1
    v_permlane16_swap_b32 v104, v114
    v_permlane16_swap_b32 v105, v115
    v_permlane16_swap_b32 v106, v116
    v_permlane16_swap_b32 v107, v117
    v_max_f32 v104, v104, v114
    v_max_f32 v105, v105, v115
    v_max_f32 v106, v106, v116
    v_max_f32 v107, v107, v117
    v_mov_b32 v28, 0
    v_mov_b32 v29, 0
    v_mov_b32 v30, 0
    v_mov_b32 v31, 0
    v_mov_b32 v32, 0
    v_mov_b32 v33, 0
    v_mov_b32 v34, 0
    v_mov_b32 v35, 0
    v_mov_b32 v36, 0
    v_mov_b32 v37, 0
    v_mov_b32 v38, 0
    v_mov_b32 v39, 0
    v_mov_b32 v40, 0
    v_mov_b32 v41, 0
    v_mov_b32 v42, 0
    v_mov_b32 v43, 0
    v_mov_b32 v128, 0
    v_mov_b32 v129, 0
    v_mov_b32 v130, 0
    v_mov_b32 v131, 0
    v_mov_b32 v132, 0
    v_mov_b32 v133, 0
    v_mov_b32 v134, 0
    v_mov_b32 v135, 0
    v_mov_b32 v136, 0
    v_mov_b32 v137, 0
    v_mov_b32 v138, 0
    v_mov_b32 v139, 0
    v_mov_b32 v140, 0
    v_mov_b32 v141, 0
    v_mov_b32 v142, 0
    v_mov_b32 v143, 0
    v_mov_b32 v144, 0
    v_mov_b32 v145, 0
    v_mov_b32 v146, 0
    v_mov_b32 v147, 0
    v_mov_b32 v148, 0
    v_mov_b32 v149, 0
    v_mov_b32 v150, 0
    v_mov_b32 v151, 0
    v_mov_b32 v152, 0
    v_mov_b32 v153, 0
    v_mov_b32 v154, 0
    v_mov_b32 v155, 0
    v_mov_b32 v156, 0
    v_mov_b32 v157, 0
    v_mov_b32 v158, 0
    v_mov_b32 v159, 0
    v_mov_b32 v160, 0
    v_mov_b32 v161, 0
    v_mov_b32 v162, 0
    v_mov_b32 v163, 0
    v_mov_b32 v164, 0
    v_mov_b32 v165, 0
    v_mov_b32 v166, 0
    v_mov_b32 v167, 0
    v_mov_b32 v168, 0
    v_mov_b32 v169, 0
    v_mov_b32 v170, 0
    v_mov_b32 v171, 0
    v_mov_b32 v172, 0
    v_mov_b32 v173, 0
    v_mov_b32 v174, 0
    v_mov_b32 v175, 0
    v_mov_b32 v176, 0
    v_mov_b32 v177, 0
    v_mov_b32 v178, 0
    v_mov_b32 v179, 0
    v_mov_b32 v180, 0
    v_mov_b32 v181, 0
    v_mov_b32 v182, 0
    v_mov_b32 v183, 0
    v_mov_b32 v184, 0
    v_mov_b32 v185, 0
    v_mov_b32 v186, 0
    v_mov_b32 v187, 0
    v_mov_b32 v188, 0
    v_mov_b32 v189, 0
    v_mov_b32 v190, 0
    v_mov_b32 v191, 0
    v_mov_b32 v192, 0
    v_mov_b32 v193, 0
    v_mov_b32 v194, 0
    v_mov_b32 v195, 0
    v_mov_b32 v196, 0
    v_mov_b32 v197, 0
    v_mov_b32 v198, 0
    v_mov_b32 v199, 0
    v_mov_b32 v200, 0
    v_mov_b32 v201, 0
    v_mov_b32 v202, 0
    v_mov_b32 v203, 0
    v_mov_b32 v204, 0
    v_mov_b32 v205, 0
    v_mov_b32 v206, 0
    v_mov_b32 v207, 0
    v_mov_b32 v208, 0
    v_mov_b32 v209, 0
    v_mov_b32 v210, 0
    v_mov_b32 v211, 0
    v_mov_b32 v212, 0
    v_mov_b32 v213, 0
    v_mov_b32 v214, 0
    v_mov_b32 v215, 0
    v_mov_b32 v216, 0
    v_mov_b32 v217, 0
    v_mov_b32 v218, 0
    v_mov_b32 v219, 0
    v_mov_b32 v220, 0
    v_mov_b32 v221, 0
    v_mov_b32 v222, 0
    v_mov_b32 v223, 0
    v_mov_b32 v224, 0
    v_mov_b32 v225, 0
    v_mov_b32 v226, 0
    v_mov_b32 v227, 0
    v_mov_b32 v228, 0
    v_mov_b32 v229, 0
    v_mov_b32 v230, 0
    v_mov_b32 v231, 0
    v_mov_b32 v232, 0
    v_mov_b32 v233, 0
    v_mov_b32 v234, 0
    v_mov_b32 v235, 0
    v_mov_b32 v236, 0
    v_mov_b32 v237, 0
    v_mov_b32 v238, 0
    v_mov_b32 v239, 0
    v_mov_b32 v240, 0
    v_mov_b32 v241, 0
    v_mov_b32 v242, 0
    v_mov_b32 v243, 0
    v_mov_b32 v244, 0
    v_mov_b32 v245, 0
    v_mov_b32 v246, 0
    v_mov_b32 v247, 0
    v_mov_b32 v248, 0
    v_mov_b32 v249, 0
    v_mov_b32 v250, 0
    v_mov_b32 v251, 0
    v_mov_b32 v252, 0
    v_mov_b32 v253, 0
    v_mov_b32 v254, 0
    v_mov_b32 v255, 0
    s_mov_b32 s73, s71
L_SLOW_P2:
    s_add_u32 m0, s45, 0
    s_add_u32 s72, s73, 0
    buffer_load_dwordx4 v108, s[8:11], s72 offen lds
    s_add_u32 m0, s45, 1024
    s_add_u32 s72, s73, 0
    buffer_load_dwordx4 v109, s[8:11], s72 offen lds
    s_add_u32 m0, s45, 2048
    s_add_u32 s72, s73, 0
    buffer_load_dwordx4 v110, s[8:11], s72 offen lds
    s_add_u32 m0, s45, 3072
    s_add_u32 s72, s73, 0
    buffer_load_dwordx4 v111, s[8:11], s72 offen lds
    s_add_u32 m0, s45, 4096
    s_add_u32 s72, s73, 4096
    buffer_load_dwordx4 v108, s[8:11], s72 offen lds
    s_add_u32 m0, s45, 5120
    s_add_u32 s72, s73, 4096
    buffer_load_dwordx4 v109, s[8:11], s72 offen lds
    s_add_u32 m0, s45, 6144
    s_add_u32 s72, s73, 4096
    buffer_load_dwordx4 v110, s[8:11], s72 offen lds
    s_add_u32 m0, s45, 7168
    s_add_u32 s72, s73, 4096
    buffer_load_dwordx4 v111, s[8:11], s72 offen lds
    s_add_u32 m0, s45, 8192
    s_add_u32 s72, s73, 0
    buffer_load_dwordx4 v112, s[12:15], s72 offen lds
    s_add_u32 m0, s45, 9216
    s_add_u32 s72, s73, 0
    buffer_load_dwordx4 v113, s[12:15], s72 offen lds
    s_add_u32 m0, s45, 10240
    s_add_u32 s72, s73, 2048
    buffer_load_dwordx4 v112, s[12:15], s72 offen lds
    s_add_u32 m0, s45, 11264
    s_add_u32 s72, s73, 2048
    buffer_load_dwordx4 v113, s[12:15], s72 offen lds
    s_add_u32 m0, s45, 12288
    s_add_u32 s72, s73, 4096
    buffer_load_dwordx4 v112, s[12:15], s72 offen lds
    s_add_u32 m0, s45, 13312
    s_add_u32 s72, s73, 4096
    buffer_load_dwordx4 v113, s[12:15], s72 offen lds
    s_add_u32 m0, s45, 14336
    s_add_u32 s72, s73, 6144
    buffer_load_dwordx4 v112, s[12:15], s72 offen lds
    s_add_u32 m0, s45, 15360
    s_add_u32 s72, s73, 6144
    buffer_load_dwordx4 v113, s[12:15], s72 offen lds
    s_waitcnt vmcnt(0)
    ds_read_b128 a[64:67], v56 offset:0
    ds_read_b128 a[68:71], v57 offset:0
    ds_read_b128 a[72:75], v58 offset:0
    ds_read_b128 a[76:79], v59 offset:0
    ds_read_b128 a[80:83], v56 offset:4096
    ds_read_b128 a[84:87], v57 offset:4096
    ds_read_b128 a[88:91], v58 offset:4096
    ds_read_b128 a[92:95], v59 offset:4096
    ds_read_b64_tr_b16 a[96:97], v96 offset:0
    ds_read_b64_tr_b16 a[98:99], v96 offset:4096
    ds_read_b64_tr_b16 a[100:101], v97 offset:0
    ds_read_b64_tr_b16 a[102:103], v97 offset:4096
    ds_read_b64_tr_b16 a[104:105], v98 offset:0
    ds_read_b64_tr_b16 a[106:107], v98 offset:4096
    ds_read_b64_tr_b16 a[108:109], v99 offset:0
    ds_read_b64_tr_b16 a[110:111], v99 offset:4096
    ds_read_b64_tr_b16 a[112:113], v100 offset:0
    ds_read_b64_tr_b16 a[114:115], v100 offset:4096
    ds_read_b64_tr_b16 a[116:117], v101 offset:0
    ds_read_b64_tr_b16 a[118:119], v101 offset:4096
    ds_read_b64_tr_b16 a[120:121], v102 offset:0
    ds_read_b64_tr_b16 a[122:123], v102 offset:4096
    ds_read_b64_tr_b16 a[124:125], v103 offset:0
    ds_read_b64_tr_b16 a[126:127], v103 offset:4096
    s_waitcnt lgkmcnt(0)
    v_mfma_f32_16x16x32_bf16 v[64:67], a[64:67], a[0:3], 0
    v_mfma_f32_16x16x32_bf16 v[64:67], a[68:71], a[4:7], v[64:67]
    v_mfma_f32_16x16x32_bf16 v[64:67], a[72:75], a[8:11], v[64:67]
    v_mfma_f32_16x16x32_bf16 v[64:67], a[76:79], a[12:15], v[64:67]
    v_mfma_f32_16x16x32_bf16 v[68:71], a[80:83], a[0:3], 0
    v_mfma_f32_16x16x32_bf16 v[68:71], a[84:87], a[4:7], v[68:71]
    v_mfma_f32_16x16x32_bf16 v[68:71], a[88:91], a[8:11], v[68:71]
    v_mfma_f32_16x16x32_bf16 v[68:71], a[92:95], a[12:15], v[68:71]
    v_mfma_f32_16x16x32_bf16 v[72:75], a[64:67], a[16:19], 0
    v_mfma_f32_16x16x32_bf16 v[72:75], a[68:71], a[20:23], v[72:75]
    v_mfma_f32_16x16x32_bf16 v[72:75], a[72:75], a[24:27], v[72:75]
    v_mfma_f32_16x16x32_bf16 v[72:75], a[76:79], a[28:31], v[72:75]
    v_mfma_f32_16x16x32_bf16 v[76:79], a[80:83], a[16:19], 0
    v_mfma_f32_16x16x32_bf16 v[76:79], a[84:87], a[20:23], v[76:79]
    v_mfma_f32_16x16x32_bf16 v[76:79], a[88:91], a[24:27], v[76:79]
    v_mfma_f32_16x16x32_bf16 v[76:79], a[92:95], a[28:31], v[76:79]
    v_mfma_f32_16x16x32_bf16 v[80:83], a[64:67], a[32:35], 0
    v_mfma_f32_16x16x32_bf16 v[80:83], a[68:71], a[36:39], v[80:83]
    v_mfma_f32_16x16x32_bf16 v[80:83], a[72:75], a[40:43], v[80:83]
    v_mfma_f32_16x16x32_bf16 v[80:83], a[76:79], a[44:47], v[80:83]
    v_mfma_f32_16x16x32_bf16 v[84:87], a[80:83], a[32:35], 0
    v_mfma_f32_16x16x32_bf16 v[84:87], a[84:87], a[36:39], v[84:87]
    v_mfma_f32_16x16x32_bf16 v[84:87], a[88:91], a[40:43], v[84:87]
    v_mfma_f32_16x16x32_bf16 v[84:87], a[92:95], a[44:47], v[84:87]
    v_mfma_f32_16x16x32_bf16 v[88:91], a[64:67], a[48:51], 0
    v_mfma_f32_16x16x32_bf16 v[88:91], a[68:71], a[52:55], v[88:91]
    v_mfma_f32_16x16x32_bf16 v[88:91], a[72:75], a[56:59], v[88:91]
    v_mfma_f32_16x16x32_bf16 v[88:91], a[76:79], a[60:63], v[88:91]
    v_mfma_f32_16x16x32_bf16 v[92:95], a[80:83], a[48:51], 0
    v_mfma_f32_16x16x32_bf16 v[92:95], a[84:87], a[52:55], v[92:95]
    v_mfma_f32_16x16x32_bf16 v[92:95], a[88:91], a[56:59], v[92:95]
    v_mfma_f32_16x16x32_bf16 v[92:95], a[92:95], a[60:63], v[92:95]
    s_nop 7
    v_sub_f32 v64, v64, v104
    v_sub_f32 v65, v65, v104
    v_sub_f32 v66, v66, v104
    v_sub_f32 v67, v67, v104
    v_sub_f32 v68, v68, v104
    v_sub_f32 v69, v69, v104
    v_sub_f32 v70, v70, v104
    v_sub_f32 v71, v71, v104
    v_exp_f32 v64, v64
    v_exp_f32 v65, v65
    v_exp_f32 v66, v66
    v_cvt_pk_bf16_f32 v64, v64, v65
    v_exp_f32 v67, v67
    v_exp_f32 v68, v68
    v_cvt_pk_bf16_f32 v65, v66, v67
    v_exp_f32 v69, v69
    v_exp_f32 v70, v70
    v_cvt_pk_bf16_f32 v66, v68, v69
    v_exp_f32 v71, v71
    s_nop 0
    v_cvt_pk_bf16_f32 v67, v70, v71
    v_sub_f32 v72, v72, v105
    v_sub_f32 v73, v73, v105
    v_sub_f32 v74, v74, v105
    v_sub_f32 v75, v75, v105
    v_sub_f32 v76, v76, v105
    v_sub_f32 v77, v77, v105
    v_sub_f32 v78, v78, v105
    v_sub_f32 v79, v79, v105
    v_exp_f32 v72, v72
    v_exp_f32 v73, v73
    v_exp_f32 v74, v74
    v_cvt_pk_bf16_f32 v72, v72, v73
    v_exp_f32 v75, v75
    v_exp_f32 v76, v76
    v_cvt_pk_bf16_f32 v73, v74, v75
    v_exp_f32 v77, v77
    v_exp_f32 v78, v78
    v_cvt_pk_bf16_f32 v74, v76, v77
    v_exp_f32 v79, v79
    s_nop 0
    v_cvt_pk_bf16_f32 v75, v78, v79
    v_sub_f32 v80, v80, v106
    v_sub_f32 v81, v81, v106
    v_sub_f32 v82, v82, v106
    v_sub_f32 v83, v83, v106
    v_sub_f32 v84, v84, v106
    v_sub_f32 v85, v85, v106
    v_sub_f32 v86, v86, v106
    v_sub_f32 v87, v87, v106
    v_exp_f32 v80, v80
    v_exp_f32 v81, v81
    v_exp_f32 v82, v82
    v_cvt_pk_bf16_f32 v80, v80, v81
    v_exp_f32 v83, v83
    v_exp_f32 v84, v84
    v_cvt_pk_bf16_f32 v81, v82, v83
    v_exp_f32 v85, v85
    v_exp_f32 v86, v86
    v_cvt_pk_bf16_f32 v82, v84, v85
    v_exp_f32 v87, v87
    s_nop 0
    v_cvt_pk_bf16_f32 v83, v86, v87
    v_sub_f32 v88, v88, v107
    v_sub_f32 v89, v89, v107
    v_sub_f32 v90, v90, v107
    v_sub_f32 v91, v91, v107
    v_sub_f32 v92, v92, v107
    v_sub_f32 v93, v93, v107
    v_sub_f32 v94, v94, v107
    v_sub_f32 v95, v95, v107
    v_exp_f32 v88, v88
    v_exp_f32 v89, v89
    v_exp_f32 v90, v90
    v_cvt_pk_bf16_f32 v88, v88, v89
    v_exp_f32 v91, v91
    v_exp_f32 v92, v92
    v_cvt_pk_bf16_f32 v89, v90, v91
    v_exp_f32 v93, v93
    v_exp_f32 v94, v94
    v_cvt_pk_bf16_f32 v90, v92, v93
    v_exp_f32 v95, v95
    s_nop 0
    v_cvt_pk_bf16_f32 v91, v94, v95
    s_nop 1
    v_mfma_f32_16x16x32_bf16 v[28:31], v[44:47], v[64:67], v[28:31]
    v_mfma_f32_16x16x32_bf16 v[128:131], a[96:99], v[64:67], v[128:131]
    v_mfma_f32_16x16x32_bf16 v[132:135], a[100:103], v[64:67], v[132:135]
    v_mfma_f32_16x16x32_bf16 v[136:139], a[104:107], v[64:67], v[136:139]
    v_mfma_f32_16x16x32_bf16 v[140:143], a[108:111], v[64:67], v[140:143]
    v_mfma_f32_16x16x32_bf16 v[144:147], a[112:115], v[64:67], v[144:147]
    v_mfma_f32_16x16x32_bf16 v[148:151], a[116:119], v[64:67], v[148:151]
    v_mfma_f32_16x16x32_bf16 v[152:155], a[120:123], v[64:67], v[152:155]
    v_mfma_f32_16x16x32_bf16 v[156:159], a[124:127], v[64:67], v[156:159]
    v_mfma_f32_16x16x32_bf16 v[32:35], v[44:47], v[72:75], v[32:35]
    v_mfma_f32_16x16x32_bf16 v[160:163], a[96:99], v[72:75], v[160:163]
    v_mfma_f32_16x16x32_bf16 v[164:167], a[100:103], v[72:75], v[164:167]
    v_mfma_f32_16x16x32_bf16 v[168:171], a[104:107], v[72:75], v[168:171]
    v_mfma_f32_16x16x32_bf16 v[172:175], a[108:111], v[72:75], v[172:175]
    v_mfma_f32_16x16x32_bf16 v[176:179], a[112:115], v[72:75], v[176:179]
    v_mfma_f32_16x16x32_bf16 v[180:183], a[116:119], v[72:75], v[180:183]
    v_mfma_f32_16x16x32_bf16 v[184:187], a[120:123], v[72:75], v[184:187]
    v_mfma_f32_16x16x32_bf16 v[188:191], a[124:127], v[72:75], v[188:191]
    v_mfma_f32_16x16x32_bf16 v[36:39], v[44:47], v[80:83], v[36:39]
    v_mfma_f32_16x16x32_bf16 v[192:195], a[96:99], v[80:83], v[192:195]
    v_mfma_f32_16x16x32_bf16 v[196:199], a[100:103], v[80:83], v[196:199]
    v_mfma_f32_16x16x32_bf16 v[200:203], a[104:107], v[80:83], v[200:203]
    v_mfma_f32_16x16x32_bf16 v[204:207], a[108:111], v[80:83], v[204:207]
    v_mfma_f32_16x16x32_bf16 v[208:211], a[112:115], v[80:83], v[208:211]
    v_mfma_f32_16x16x32_bf16 v[212:215], a[116:119], v[80:83], v[212:215]
    v_mfma_f32_16x16x32_bf16 v[216:219], a[120:123], v[80:83], v[216:219]
    v_mfma_f32_16x16x32_bf16 v[220:223], a[124:127], v[80:83], v[220:223]
    v_mfma_f32_16x16x32_bf16 v[40:43], v[44:47], v[88:91], v[40:43]
    v_mfma_f32_16x16x32_bf16 v[224:227], a[96:99], v[88:91], v[224:227]
    v_mfma_f32_16x16x32_bf16 v[228:231], a[100:103], v[88:91], v[228:231]
    v_mfma_f32_16x16x32_bf16 v[232:235], a[104:107], v[88:91], v[232:235]
    v_mfma_f32_16x16x32_bf16 v[236:239], a[108:111], v[88:91], v[236:239]
    v_mfma_f32_16x16x32_bf16 v[240:243], a[112:115], v[88:91], v[240:243]
    v_mfma_f32_16x16x32_bf16 v[244:247], a[116:119], v[88:91], v[244:247]
    v_mfma_f32_16x16x32_bf16 v[248:251], a[120:123], v[88:91], v[248:251]
    v_mfma_f32_16x16x32_bf16 v[252:255], a[124:127], v[88:91], v[252:255]
    s_add_u32 s73, s73, 8192
    s_cmp_lt_u32 s73, s74
    s_nop 4
    s_cbranch_scc1 L_SLOW_P2
    s_nop 7
    v_and_b32 v57, 15, v0
    v_bfe_u32 v56, v0, 5, 1
    v_bfe_u32 v58, v0, 4, 1
    v_xor_b32 v56, v56, v57
    v_lshlrev_b32 v56, 4, v56
    v_lshl_add_u32 v56, v58, 3, v56
    v_lshl_add_u32 v56, v57, 8, v56
    v_add_u32 v56, s45, v56
    v_xor_b32 v63, 224, v56
    v_xor_b32 v62, 192, v56
    v_xor_b32 v61, 160, v56
    v_xor_b32 v60, 128, v56
    v_xor_b32 v59, 96, v56
    v_xor_b32 v58, 64, v56
    v_xor_b32 v57, 32, v56
    v_rcp_f32 v30, v28
    s_nop 0
    v_pk_mul_f32 v[128:129], v[128:129], v[30:31] op_sel_hi:[1,0]
    v_pk_mul_f32 v[130:131], v[130:131], v[30:31] op_sel_hi:[1,0]
    v_pk_mul_f32 v[132:133], v[132:133], v[30:31] op_sel_hi:[1,0]
    v_pk_mul_f32 v[134:135], v[134:135], v[30:31] op_sel_hi:[1,0]
    v_cvt_pk_bf16_f32 v128, v128, v129
    v_cvt_pk_bf16_f32 v129, v130, v131
    v_cvt_pk_bf16_f32 v132, v132, v133
    v_cvt_pk_bf16_f32 v133, v134, v135
    v_pk_mul_f32 v[136:137], v[136:137], v[30:31] op_sel_hi:[1,0]
    v_pk_mul_f32 v[138:139], v[138:139], v[30:31] op_sel_hi:[1,0]
    v_pk_mul_f32 v[140:141], v[140:141], v[30:31] op_sel_hi:[1,0]
    v_pk_mul_f32 v[142:143], v[142:143], v[30:31] op_sel_hi:[1,0]
    ds_write_b64 v56, v[128:129] offset:0
    ds_write_b64 v57, v[132:133] offset:0
    v_cvt_pk_bf16_f32 v136, v136, v137
    v_cvt_pk_bf16_f32 v137, v138, v139
    v_cvt_pk_bf16_f32 v140, v140, v141
    v_cvt_pk_bf16_f32 v141, v142, v143
    v_pk_mul_f32 v[144:145], v[144:145], v[30:31] op_sel_hi:[1,0]
    v_pk_mul_f32 v[146:147], v[146:147], v[30:31] op_sel_hi:[1,0]
    v_pk_mul_f32 v[148:149], v[148:149], v[30:31] op_sel_hi:[1,0]
    v_pk_mul_f32 v[150:151], v[150:151], v[30:31] op_sel_hi:[1,0]
    ds_write_b64 v58, v[136:137] offset:0
    ds_write_b64 v59, v[140:141] offset:0
    v_cvt_pk_bf16_f32 v144, v144, v145
    v_cvt_pk_bf16_f32 v145, v146, v147
    v_cvt_pk_bf16_f32 v148, v148, v149
    v_cvt_pk_bf16_f32 v149, v150, v151
    v_pk_mul_f32 v[152:153], v[152:153], v[30:31] op_sel_hi:[1,0]
    v_pk_mul_f32 v[154:155], v[154:155], v[30:31] op_sel_hi:[1,0]
    v_pk_mul_f32 v[156:157], v[156:157], v[30:31] op_sel_hi:[1,0]
    v_pk_mul_f32 v[158:159], v[158:159], v[30:31] op_sel_hi:[1,0]
    ds_write_b64 v60, v[144:145] offset:0
    ds_write_b64 v61, v[148:149] offset:0
    v_cvt_pk_bf16_f32 v152, v152, v153
    v_cvt_pk_bf16_f32 v153, v154, v155
    v_cvt_pk_bf16_f32 v156, v156, v157
    v_cvt_pk_bf16_f32 v157, v158, v159
    ds_write_b64 v62, v[152:153] offset:0
    ds_write_b64 v63, v[156:157] offset:0
    s_waitcnt lgkmcnt(0)
    ds_read_b128 v[136:139], v2 offset:0
    ds_read_b128 v[140:143], v2 offset:1024
    ds_read_b128 v[144:147], v2 offset:2048
    ds_read_b128 v[148:151], v2 offset:3072
    s_waitcnt lgkmcnt(0)
    buffer_store_dwordx4 v[136:139], v20, s[20:23], s64 offen sc0 sc1
    buffer_store_dwordx4 v[140:143], v21, s[20:23], s64 offen sc0 sc1
    buffer_store_dwordx4 v[144:147], v22, s[20:23], s64 offen sc0 sc1
    buffer_store_dwordx4 v[148:151], v23, s[20:23], s64 offen sc0 sc1
    v_rcp_f32 v34, v32
    s_nop 0
    v_pk_mul_f32 v[160:161], v[160:161], v[34:35] op_sel_hi:[1,0]
    v_pk_mul_f32 v[162:163], v[162:163], v[34:35] op_sel_hi:[1,0]
    v_pk_mul_f32 v[164:165], v[164:165], v[34:35] op_sel_hi:[1,0]
    v_pk_mul_f32 v[166:167], v[166:167], v[34:35] op_sel_hi:[1,0]
    v_cvt_pk_bf16_f32 v160, v160, v161
    v_cvt_pk_bf16_f32 v161, v162, v163
    v_cvt_pk_bf16_f32 v164, v164, v165
    v_cvt_pk_bf16_f32 v165, v166, v167
    v_pk_mul_f32 v[168:169], v[168:169], v[34:35] op_sel_hi:[1,0]
    v_pk_mul_f32 v[170:171], v[170:171], v[34:35] op_sel_hi:[1,0]
    v_pk_mul_f32 v[172:173], v[172:173], v[34:35] op_sel_hi:[1,0]
    v_pk_mul_f32 v[174:175], v[174:175], v[34:35] op_sel_hi:[1,0]
    ds_write_b64 v56, v[160:161] offset:4096
    ds_write_b64 v57, v[164:165] offset:4096
    v_cvt_pk_bf16_f32 v168, v168, v169
    v_cvt_pk_bf16_f32 v169, v170, v171
    v_cvt_pk_bf16_f32 v172, v172, v173
    v_cvt_pk_bf16_f32 v173, v174, v175
    v_pk_mul_f32 v[176:177], v[176:177], v[34:35] op_sel_hi:[1,0]
    v_pk_mul_f32 v[178:179], v[178:179], v[34:35] op_sel_hi:[1,0]
    v_pk_mul_f32 v[180:181], v[180:181], v[34:35] op_sel_hi:[1,0]
    v_pk_mul_f32 v[182:183], v[182:183], v[34:35] op_sel_hi:[1,0]
    ds_write_b64 v58, v[168:169] offset:4096
    ds_write_b64 v59, v[172:173] offset:4096
    v_cvt_pk_bf16_f32 v176, v176, v177
    v_cvt_pk_bf16_f32 v177, v178, v179
    v_cvt_pk_bf16_f32 v180, v180, v181
    v_cvt_pk_bf16_f32 v181, v182, v183
    v_pk_mul_f32 v[184:185], v[184:185], v[34:35] op_sel_hi:[1,0]
    v_pk_mul_f32 v[186:187], v[186:187], v[34:35] op_sel_hi:[1,0]
    v_pk_mul_f32 v[188:189], v[188:189], v[34:35] op_sel_hi:[1,0]
    v_pk_mul_f32 v[190:191], v[190:191], v[34:35] op_sel_hi:[1,0]
    ds_write_b64 v60, v[176:177] offset:4096
    ds_write_b64 v61, v[180:181] offset:4096
    v_cvt_pk_bf16_f32 v184, v184, v185
    v_cvt_pk_bf16_f32 v185, v186, v187
    v_cvt_pk_bf16_f32 v188, v188, v189
    v_cvt_pk_bf16_f32 v189, v190, v191
    ds_write_b64 v62, v[184:185] offset:4096
    ds_write_b64 v63, v[188:189] offset:4096
    s_waitcnt lgkmcnt(0)
    ds_read_b128 v[168:171], v2 offset:4096
    ds_read_b128 v[172:175], v2 offset:5120
    ds_read_b128 v[176:179], v2 offset:6144
    ds_read_b128 v[180:183], v2 offset:7168
    s_waitcnt lgkmcnt(0)
    buffer_store_dwordx4 v[168:171], v20, s[20:23], s65 offen sc0 sc1
    buffer_store_dwordx4 v[172:175], v21, s[20:23], s65 offen sc0 sc1
    buffer_store_dwordx4 v[176:179], v22, s[20:23], s65 offen sc0 sc1
    buffer_store_dwordx4 v[180:183], v23, s[20:23], s65 offen sc0 sc1
    v_rcp_f32 v38, v36
    s_nop 0
    v_pk_mul_f32 v[192:193], v[192:193], v[38:39] op_sel_hi:[1,0]
    v_pk_mul_f32 v[194:195], v[194:195], v[38:39] op_sel_hi:[1,0]
    v_pk_mul_f32 v[196:197], v[196:197], v[38:39] op_sel_hi:[1,0]
    v_pk_mul_f32 v[198:199], v[198:199], v[38:39] op_sel_hi:[1,0]
    v_cvt_pk_bf16_f32 v192, v192, v193
    v_cvt_pk_bf16_f32 v193, v194, v195
    v_cvt_pk_bf16_f32 v196, v196, v197
    v_cvt_pk_bf16_f32 v197, v198, v199
    v_pk_mul_f32 v[200:201], v[200:201], v[38:39] op_sel_hi:[1,0]
    v_pk_mul_f32 v[202:203], v[202:203], v[38:39] op_sel_hi:[1,0]
    v_pk_mul_f32 v[204:205], v[204:205], v[38:39] op_sel_hi:[1,0]
    v_pk_mul_f32 v[206:207], v[206:207], v[38:39] op_sel_hi:[1,0]
    ds_write_b64 v56, v[192:193] offset:8192
    ds_write_b64 v57, v[196:197] offset:8192
    v_cvt_pk_bf16_f32 v200, v200, v201
    v_cvt_pk_bf16_f32 v201, v202, v203
    v_cvt_pk_bf16_f32 v204, v204, v205
    v_cvt_pk_bf16_f32 v205, v206, v207
    v_pk_mul_f32 v[208:209], v[208:209], v[38:39] op_sel_hi:[1,0]
    v_pk_mul_f32 v[210:211], v[210:211], v[38:39] op_sel_hi:[1,0]
    v_pk_mul_f32 v[212:213], v[212:213], v[38:39] op_sel_hi:[1,0]
    v_pk_mul_f32 v[214:215], v[214:215], v[38:39] op_sel_hi:[1,0]
    ds_write_b64 v58, v[200:201] offset:8192
    ds_write_b64 v59, v[204:205] offset:8192
    v_cvt_pk_bf16_f32 v208, v208, v209
    v_cvt_pk_bf16_f32 v209, v210, v211
    v_cvt_pk_bf16_f32 v212, v212, v213
    v_cvt_pk_bf16_f32 v213, v214, v215
    v_pk_mul_f32 v[216:217], v[216:217], v[38:39] op_sel_hi:[1,0]
    v_pk_mul_f32 v[218:219], v[218:219], v[38:39] op_sel_hi:[1,0]
    v_pk_mul_f32 v[220:221], v[220:221], v[38:39] op_sel_hi:[1,0]
    v_pk_mul_f32 v[222:223], v[222:223], v[38:39] op_sel_hi:[1,0]
    ds_write_b64 v60, v[208:209] offset:8192
    ds_write_b64 v61, v[212:213] offset:8192
    v_cvt_pk_bf16_f32 v216, v216, v217
    v_cvt_pk_bf16_f32 v217, v218, v219
    v_cvt_pk_bf16_f32 v220, v220, v221
    v_cvt_pk_bf16_f32 v221, v222, v223
    ds_write_b64 v62, v[216:217] offset:8192
    ds_write_b64 v63, v[220:221] offset:8192
    s_waitcnt lgkmcnt(0)
    ds_read_b128 v[200:203], v2 offset:8192
    ds_read_b128 v[204:207], v2 offset:9216
    ds_read_b128 v[208:211], v2 offset:10240
    ds_read_b128 v[212:215], v2 offset:11264
    s_waitcnt lgkmcnt(0)
    buffer_store_dwordx4 v[200:203], v20, s[20:23], s66 offen sc0 sc1
    buffer_store_dwordx4 v[204:207], v21, s[20:23], s66 offen sc0 sc1
    buffer_store_dwordx4 v[208:211], v22, s[20:23], s66 offen sc0 sc1
    buffer_store_dwordx4 v[212:215], v23, s[20:23], s66 offen sc0 sc1
    v_rcp_f32 v42, v40
    s_nop 0
    v_pk_mul_f32 v[224:225], v[224:225], v[42:43] op_sel_hi:[1,0]
    v_pk_mul_f32 v[226:227], v[226:227], v[42:43] op_sel_hi:[1,0]
    v_pk_mul_f32 v[228:229], v[228:229], v[42:43] op_sel_hi:[1,0]
    v_pk_mul_f32 v[230:231], v[230:231], v[42:43] op_sel_hi:[1,0]
    v_cvt_pk_bf16_f32 v224, v224, v225
    v_cvt_pk_bf16_f32 v225, v226, v227
    v_cvt_pk_bf16_f32 v228, v228, v229
    v_cvt_pk_bf16_f32 v229, v230, v231
    v_pk_mul_f32 v[232:233], v[232:233], v[42:43] op_sel_hi:[1,0]
    v_pk_mul_f32 v[234:235], v[234:235], v[42:43] op_sel_hi:[1,0]
    v_pk_mul_f32 v[236:237], v[236:237], v[42:43] op_sel_hi:[1,0]
    v_pk_mul_f32 v[238:239], v[238:239], v[42:43] op_sel_hi:[1,0]
    ds_write_b64 v56, v[224:225] offset:12288
    ds_write_b64 v57, v[228:229] offset:12288
    v_cvt_pk_bf16_f32 v232, v232, v233
    v_cvt_pk_bf16_f32 v233, v234, v235
    v_cvt_pk_bf16_f32 v236, v236, v237
    v_cvt_pk_bf16_f32 v237, v238, v239
    v_pk_mul_f32 v[240:241], v[240:241], v[42:43] op_sel_hi:[1,0]
    v_pk_mul_f32 v[242:243], v[242:243], v[42:43] op_sel_hi:[1,0]
    v_pk_mul_f32 v[244:245], v[244:245], v[42:43] op_sel_hi:[1,0]
    v_pk_mul_f32 v[246:247], v[246:247], v[42:43] op_sel_hi:[1,0]
    ds_write_b64 v58, v[232:233] offset:12288
    ds_write_b64 v59, v[236:237] offset:12288
    v_cvt_pk_bf16_f32 v240, v240, v241
    v_cvt_pk_bf16_f32 v241, v242, v243
    v_cvt_pk_bf16_f32 v244, v244, v245
    v_cvt_pk_bf16_f32 v245, v246, v247
    v_pk_mul_f32 v[248:249], v[248:249], v[42:43] op_sel_hi:[1,0]
    v_pk_mul_f32 v[250:251], v[250:251], v[42:43] op_sel_hi:[1,0]
    v_pk_mul_f32 v[252:253], v[252:253], v[42:43] op_sel_hi:[1,0]
    v_pk_mul_f32 v[254:255], v[254:255], v[42:43] op_sel_hi:[1,0]
    ds_write_b64 v60, v[240:241] offset:12288
    ds_write_b64 v61, v[244:245] offset:12288
    v_cvt_pk_bf16_f32 v248, v248, v249
    v_cvt_pk_bf16_f32 v249, v250, v251
    v_cvt_pk_bf16_f32 v252, v252, v253
    v_cvt_pk_bf16_f32 v253, v254, v255
    ds_write_b64 v62, v[248:249] offset:12288
    ds_write_b64 v63, v[252:253] offset:12288
    s_waitcnt lgkmcnt(0)
    ds_read_b128 v[232:235], v2 offset:12288
    ds_read_b128 v[236:239], v2 offset:13312
    ds_read_b128 v[240:243], v2 offset:14336
    ds_read_b128 v[244:247], v2 offset:15360
    s_waitcnt lgkmcnt(0)
    buffer_store_dwordx4 v[232:235], v20, s[20:23], s67 offen sc0 sc1
    buffer_store_dwordx4 v[236:239], v21, s[20:23], s67 offen sc0 sc1
    buffer_store_dwordx4 v[240:243], v22, s[20:23], s67 offen sc0 sc1
    buffer_store_dwordx4 v[244:247], v23, s[20:23], s67 offen sc0 sc1
    s_waitcnt vmcnt(0)
L_SLOW_NEXT:
    s_add_u32 s70, s70, 1
    s_cmp_lt_u32 s70, 2
    s_cbranch_scc1 L_SLOW_UNIT
L_END:
    s_endpgm
L_CODE_END:
.section .rodata,"a"
.p2align 6
.amdhsa_kernel standalone__gqa_softmax__near_ridge_kernel
  .amdhsa_next_free_vgpr 512
  .amdhsa_next_free_sgpr 102
  .amdhsa_accum_offset 256
  .amdhsa_group_segment_fixed_size 0
  .amdhsa_kernarg_size 48
  .amdhsa_user_sgpr_count 2
  .amdhsa_user_sgpr_kernarg_segment_ptr 1
  .amdhsa_system_sgpr_workgroup_id_x 1
  .amdhsa_float_denorm_mode_32 3
.end_amdhsa_kernel
```
